```python
import torch

def _softmax(x, axis=-1):
    return torch.softmax(x, dim=axis)
def _gelu(x):
    return torch.nn.functional.gelu(x, approximate="tanh")
def _silu(x):
    return torch.nn.functional.silu(x)
def _sigmoid(x):
    return torch.sigmoid(x)
def _layernorm(x, axis=-1, eps=1e-5):
    m = x.mean(dim=axis, keepdim=True)
    v = x.var(dim=axis, keepdim=True, unbiased=False)
    return (x - m) / torch.sqrt(v + eps)
def _scatter_add(tgt, idx, src, axis=0):
    return tgt.clone().index_add_(axis, idx, src)
def _segment_sum(src, seg, n):
    out = torch.zeros((n,) + src.shape[1:], dtype=src.dtype)
    return out.index_add_(0, seg, src)
def _pad(x, pw):
    flat = tuple(v for pair in reversed(pw) for v in pair)
    return torch.nn.functional.pad(x, flat)

kernel_name = 'standalone__deep_cross_pnn__recsys'

def setup_inputs():

    _w = (lambda a: (lambda t: t.to(torch.bfloat16) if t.is_floating_point() else t)(torch.as_tensor(a)))
    B, F, D, V = 16384, 100, 32, min(1000000, 100000)
    H = 4 * D
    return {
        "idx": _w((lambda lo, hi, *s: torch.randint(lo, hi, s))(0, V, B, F).to(torch.int64)),
        "table": _w((lambda *s: torch.randn(*s, dtype=torch.bfloat16) * 1.6)(V, D) * (D ** -0.5)),
        "w_p": _w((lambda *s: torch.randn(*s, dtype=torch.bfloat16) * 0.05)(F * F) * ((F * F) ** -0.5)),
        "w1": _w((lambda *s: torch.randn(*s, dtype=torch.bfloat16) * 1.6)(F * D, H) * ((F * D) ** -0.5)),
        "b1": _w((lambda *s: torch.randn(*s, dtype=torch.bfloat16) * 1.6)(H) * 0.01),
        "w2": _w((lambda *s: torch.randn(*s, dtype=torch.bfloat16) * 0.05)(H) * (H ** -0.5)),
        "b2": _w((lambda *s: torch.randn(*s, dtype=torch.bfloat16) * 0.05)(1) * 0.01),
    }

def reference(idx, table, w_p, w1, b1, w2, b2):
    emb = table[idx]
    B = emb.shape[0]; F = emb.shape[1]; D = emb.shape[2]
    ip = torch.einsum('bid,bjd->bij', emb, emb)
    ip = ip.reshape(B, F * F)
    logit_p = ip @ w_p
    z = emb.reshape(B, F * D)
    h = _gelu(z @ w1 + b1)
    logit_d = h @ w2 + b2
    return logit_p + logit_d
```

```asm
; @launch grid=(256,1,1) block=(256,1,1) lds=163328
.amdgcn_target "amdgcn-amd-amdhsa--gfx950"
.text
.globl standalone__deep_cross_pnn__recsys_kernel
.p2align 8
.type standalone__deep_cross_pnn__recsys_kernel,@function
standalone__deep_cross_pnn__recsys_kernel:
L_start:
  s_cmp_ge_u32 s2, 256
  s_cbranch_scc1 L_end
  s_load_dwordx16 s[4:19], s[0:1], 0
  s_load_dwordx4 s[20:23], s[0:1], 64
  v_lshrrev_b32 v9, 6, v0
  v_and_b32 v0, 63, v0
  v_readfirstlane_b32 s40, v9
  v_lshlrev_b32 v4, 4, v0
  s_getpc_b64 s[46:47]
L_pc:
  s_sub_u32 s46, s46, L_pc-L_start
  s_subb_u32 s47, s47, 0
  s_lshr_b32 s48, s2, 3
  s_and_b32 s48, s48, 31
  s_lshl_b32 s48, s48, 10
  s_lshl_b32 s49, s40, 8
  s_add_u32 s48, s48, s49
  s_sub_u32 s48, s48, 1280
  s_lshl_b32 s49, s40, 9
  v_lshl_add_u32 v2, v0, 7, s49
  v_lshl_add_u32 v3, v0, 7, s48
  s_mul_i32 s49, s40, 768
  s_add_u32 s49, s49, L_prod-L_start-512
  v_lshl_add_u32 v5, v0, 7, s49
  v_cmp_gt_u32 vcc, 4, v0
  s_nop 1
  v_cndmask_b32 v5, v5, v2, vcc
  v_cmp_gt_u32 vcc, 10, v0
  s_nop 1
  v_cndmask_b32 v5, v3, v5, vcc
  v_min_u32 v5, L_codeend-L_start-4, v5
  s_mov_b64 exec, 0xfff
  global_load_dword v123, v5, s[46:47]
  s_mov_b64 exec, -1
  s_mul_i32 s44, s40, 16640
  s_lshl_b32 s42, s2, 6
  s_lshl_b32 s45, s40, 4
  s_add_u32 s42, s42, s45
  s_mul_i32 s42, s42, 400
  s_add_u32 m0, s44, 66560
  s_mov_b32 s26, 6553600
  s_mov_b32 s27, 0x00020000
  s_add_u32 s45, s42, 4096
  s_lshr_b32 s63, s2, 3
  s_lshl_b32 s63, s63, 2
  s_and_b32 s46, s2, 3
  s_or_b32 s63, s63, s46
  s_and_b32 s46, s2, 4
  s_lshl_b32 s46, s46, 6
  s_or_b32 s63, s63, s46
  s_cmp_lt_u32 s63, 56
  s_waitcnt lgkmcnt(0)
  s_cbranch_scc1 L_prod
  s_mov_b32 s24, s4
  s_and_b32 s25, s5, 0xffff
  buffer_load_dwordx4 v4, s[24:27], s42 offen offset:0 nt lds
  buffer_load_dwordx4 v4, s[24:27], s42 offen offset:1024 nt lds
  buffer_load_dwordx4 v4, s[24:27], s42 offen offset:2048 nt lds
  buffer_load_dwordx4 v4, s[24:27], s42 offen offset:3072 nt lds
  s_add_u32 m0, m0, 4096
  s_nop 0
  buffer_load_dwordx4 v4, s[24:27], s45 offen offset:0 nt lds
  buffer_load_dwordx4 v4, s[24:27], s45 offen offset:1024 nt lds
  s_mov_b64 exec, 0xffff
  buffer_load_dwordx4 v4, s[24:27], s45 offen offset:2048 nt lds
  s_mov_b64 exec, -1
  s_mov_b32 s28, s6
  s_and_b32 s29, s7, 0xffff
  s_mov_b32 s30, 6400000
  s_mov_b32 s31, 0x00020000
  v_and_b32 v2, 3, v0
  v_lshrrev_b32 v3, 4, v0
  v_sub_u32 v1, 0, v3
  v_and_b32 v1, 3, v1
  v_xor_b32 v1, v1, v2
  v_lshlrev_b32 v1, 4, v1
  v_xor_b32 v6, 16, v1
  v_mul_u32_u24 v5, 400, v2
  v_lshrrev_b32 v8, 2, v0
  v_lshl_add_u32 v5, v8, 2, v5
  s_add_u32 s45, s44, 66560
  v_add_u32 v5, s45, v5
  v_mul_u32_u24 v7, 1600, v2
  v_and_b32 v8, 3, v8
  v_mul_u32_u24 v8, 400, v8
  v_add_u32 v7, v7, v8
  v_lshl_add_u32 v7, v3, 2, v7
  v_add_u32 v7, s45, v7
  s_lshl_b32 s74, s40, 12
  s_add_u32 s74, s74, 145408
  s_waitcnt vmcnt(0)
  ds_read_b32 v32, v7 offset:384
  ds_read_b32 v192, v5 offset:0
  ds_read_b32 v196, v5 offset:1600
  ds_read_b32 v200, v5 offset:3200
  ds_read_b32 v204, v5 offset:4800
  ds_read_b32 v193, v5 offset:64
  ds_read_b32 v197, v5 offset:1664
  ds_read_b32 v201, v5 offset:3264
  ds_read_b32 v205, v5 offset:4864
  ds_read_b32 v194, v5 offset:128
  ds_read_b32 v198, v5 offset:1728
  ds_read_b32 v202, v5 offset:3328
  ds_read_b32 v206, v5 offset:4928
  s_waitcnt lgkmcnt(12)
  v_lshlrev_b32 v32, 6, v32
  s_add_u32 m0, s74, 0
  s_nop 0
  v_add_u32_dpp v2, v32, v1 quad_perm:[0,0,0,0] row_mask:0xf bank_mask:0xf
  buffer_load_dwordx4 v2, s[28:31], 0 offen lds
  s_add_u32 m0, s74, 1024
  v_add_u32_dpp v3, v32, v1 quad_perm:[1,1,1,1] row_mask:0xf bank_mask:0xf
  buffer_load_dwordx4 v3, s[28:31], 0 offen lds
  s_add_u32 m0, s74, 2048
  v_add_u32_dpp v2, v32, v1 quad_perm:[2,2,2,2] row_mask:0xf bank_mask:0xf
  buffer_load_dwordx4 v2, s[28:31], 0 offen lds
  s_add_u32 m0, s74, 3072
  v_add_u32_dpp v3, v32, v1 quad_perm:[3,3,3,3] row_mask:0xf bank_mask:0xf
  buffer_load_dwordx4 v3, s[28:31], 0 offen lds
  s_waitcnt lgkmcnt(11)
  v_lshlrev_b32 v192, 6, v192
  s_add_u32 m0, s44, 0
  s_nop 0
  v_add_u32_dpp v2, v192, v1 quad_perm:[0,0,0,0] row_mask:0xf bank_mask:0xf
  buffer_load_dwordx4 v2, s[28:31], 0 offen lds
  s_mov_b32 s32, s22
  s_and_b32 s33, s23, 0xffff
  s_mov_b32 s34, 849920
  s_mov_b32 s35, 0x00020000
  s_mov_b32 s68, s20
  s_and_b32 s69, s21, 0xffff
  s_mov_b32 s70, 256
  s_mov_b32 s71, 0x00020000
  s_and_b32 s45, s2, 1
  s_lshl_b32 s45, s45, 7
  v_mov_b32 v120, s45
  s_waitcnt lgkmcnt(0)
  ds_read_b32 v195, v5 offset:192
  ds_read_b32 v199, v5 offset:1792
  ds_read_b32 v203, v5 offset:3392
  ds_read_b32 v207, v5 offset:4992
  ds_read_b32 v252, v5 offset:256
  ds_read_b32 v253, v5 offset:1856
  ds_read_b32 v254, v5 offset:3456
  ds_read_b32 v255, v5 offset:5056
  ds_read_b32 v92, v5 offset:320
  ds_read_b32 v93, v5 offset:1920
  ds_read_b32 v94, v5 offset:3520
  ds_read_b32 v95, v5 offset:5120
  s_add_u32 m0, s44, 1040
  v_add_u32_dpp v3, v192, v1 quad_perm:[1,1,1,1] row_mask:0xf bank_mask:0xf
  buffer_load_dwordx4 v3, s[28:31], 0 offen lds
  s_add_u32 m0, s44, 2080
  v_add_u32_dpp v2, v192, v1 quad_perm:[2,2,2,2] row_mask:0xf bank_mask:0xf
  buffer_load_dwordx4 v2, s[28:31], 0 offen lds
  s_add_u32 m0, s44, 3120
  v_add_u32_dpp v3, v192, v1 quad_perm:[3,3,3,3] row_mask:0xf bank_mask:0xf
  buffer_load_dwordx4 v3, s[28:31], 0 offen lds
  v_lshlrev_b32 v196, 6, v196
  s_add_u32 m0, s44, 4160
  s_nop 0
  v_add_u32_dpp v2, v196, v6 quad_perm:[0,0,0,0] row_mask:0xf bank_mask:0xf
  buffer_load_dwordx4 v2, s[28:31], 0 offen lds
  s_add_u32 m0, s44, 5200
  v_add_u32_dpp v3, v196, v6 quad_perm:[1,1,1,1] row_mask:0xf bank_mask:0xf
  buffer_load_dwordx4 v3, s[28:31], 0 offen lds
  s_add_u32 m0, s44, 6240
  v_add_u32_dpp v2, v196, v6 quad_perm:[2,2,2,2] row_mask:0xf bank_mask:0xf
  buffer_load_dwordx4 v2, s[28:31], 0 offen lds
  s_add_u32 m0, s44, 7280
  v_add_u32_dpp v3, v196, v6 quad_perm:[3,3,3,3] row_mask:0xf bank_mask:0xf
  buffer_load_dwordx4 v3, s[28:31], 0 offen lds
  v_lshlrev_b32 v200, 6, v200
  s_add_u32 m0, s44, 8320
  s_nop 0
  v_add_u32_dpp v2, v200, v6 quad_perm:[0,0,0,0] row_mask:0xf bank_mask:0xf
  buffer_load_dwordx4 v2, s[28:31], 0 offen lds
  s_add_u32 m0, s44, 9360
  v_add_u32_dpp v3, v200, v6 quad_perm:[1,1,1,1] row_mask:0xf bank_mask:0xf
  buffer_load_dwordx4 v3, s[28:31], 0 offen lds
  s_add_u32 m0, s44, 10400
  v_add_u32_dpp v2, v200, v6 quad_perm:[2,2,2,2] row_mask:0xf bank_mask:0xf
  buffer_load_dwordx4 v2, s[28:31], 0 offen lds
  s_add_u32 m0, s44, 11440
  v_add_u32_dpp v3, v200, v6 quad_perm:[3,3,3,3] row_mask:0xf bank_mask:0xf
  buffer_load_dwordx4 v3, s[28:31], 0 offen lds
  v_lshlrev_b32 v204, 6, v204
  s_add_u32 m0, s44, 12480
  s_nop 0
  v_add_u32_dpp v2, v204, v1 quad_perm:[0,0,0,0] row_mask:0xf bank_mask:0xf
  buffer_load_dwordx4 v2, s[28:31], 0 offen lds
  s_add_u32 m0, s44, 13520
  v_add_u32_dpp v3, v204, v1 quad_perm:[1,1,1,1] row_mask:0xf bank_mask:0xf
  buffer_load_dwordx4 v3, s[28:31], 0 offen lds
  s_add_u32 m0, s44, 14560
  v_add_u32_dpp v2, v204, v1 quad_perm:[2,2,2,2] row_mask:0xf bank_mask:0xf
  buffer_load_dwordx4 v2, s[28:31], 0 offen lds
  s_add_u32 m0, s44, 15600
  v_add_u32_dpp v3, v204, v1 quad_perm:[3,3,3,3] row_mask:0xf bank_mask:0xf
  buffer_load_dwordx4 v3, s[28:31], 0 offen lds
  s_cmp_lg_u32 s40, 0
  s_cbranch_scc1 L_np
  buffer_load_dword v112, v120, s[68:71], 0 offen sc1
L_np:
  s_lshl_b32 s41, s40, 10
  s_mul_i32 s43, s40, 205824
  s_add_u32 s43, s43, 196608
  s_add_u32 s62, s43, 4096
  s_add_u32 s73, s41, 823296
  v_lshrrev_b32 v2, 4, v0
  v_lshlrev_b32 v2, 5, v2
  s_lshr_b32 s45, s40, 1
  s_lshl_b32 s45, s45, 7
  s_and_b32 s75, s40, 1
  s_lshl_b32 s75, s75, 2
  s_add_u32 s75, s75, s45
  v_add_u32 v2, s75, v2
  s_mov_b32 s36, s12
  s_and_b32 s37, s13, 0xffff
  s_mov_b32 s38, 256
  s_mov_b32 s39, 0x00020000
  buffer_load_dword v96, v2, s[36:39], 0 offen offset:0
  buffer_load_dword v97, v2, s[36:39], 0 offen offset:8
  buffer_load_dword v98, v2, s[36:39], 0 offen offset:16
  buffer_load_dword v99, v2, s[36:39], 0 offen offset:24
  s_mov_b32 s36, s16
  s_and_b32 s37, s17, 0xffff
  s_mov_b32 s38, 2
  s_mov_b32 s39, 0x00020000
  buffer_load_ushort v121, off, s[36:39], 0
  s_mov_b32 s36, s14
  s_and_b32 s37, s15, 0xffff
  s_mov_b32 s38, 256
  s_mov_b32 s39, 0x00020000
  s_mov_b32 m0, 161792
  v_lshlrev_b32 v2, 2, v0
  buffer_load_dword v2, s[36:39], 0 offen lds
L_join:
  s_nop 1
  v_lshrrev_b32 v3, 4, v0
  v_lshlrev_b32 v7, 4, v3
  v_bfe_u32 v2, v0, 2, 2
  v_sub_u32 v9, 0, v2
  v_and_b32 v9, 3, v9
  v_xor_b32 v9, v9, v3
  v_and_b32 v8, 15, v0
  v_lshlrev_b32 v8, 6, v8
  v_lshl_add_u32 v8, v9, 4, v8
  v_add_u32 v33, s74, v8
  v_add_u32 v8, s44, v8
  v_add_u32 v9, 66560, v8
  v_bfe_u32 v11, v0, 2, 2
  v_lshlrev_b32 v11, 10, v11
  v_and_b32 v2, 3, v0
  v_lshl_add_u32 v11, v2, 6, v11
  v_add_u32 v11, 145408, v11
  v_add_u32 v10, 133120, v4
  v_mov_b32 v16, 0
  v_mov_b32 v17, 0
  v_mov_b32 v18, 0
  v_mov_b32 v19, 0
  v_mov_b32 v20, 0
  v_mov_b32 v21, 0
  v_mov_b32 v22, 0
  v_mov_b32 v23, 0
  v_mov_b32 v24, 0
  v_mov_b32 v25, 0
  v_mov_b32 v26, 0
  v_mov_b32 v27, 0
  v_mov_b32 v28, 0
  v_mov_b32 v29, 0
  v_mov_b32 v30, 0
  v_mov_b32 v31, 0
  v_lshlrev_b32 v193, 6, v193
  v_lshlrev_b32 v197, 6, v197
  v_lshlrev_b32 v201, 6, v201
  v_lshlrev_b32 v205, 6, v205
  v_lshlrev_b32 v194, 6, v194
  v_lshlrev_b32 v198, 6, v198
  v_lshlrev_b32 v202, 6, v202
  v_lshlrev_b32 v206, 6, v206
  s_waitcnt lgkmcnt(11)
  v_lshlrev_b32 v195, 6, v195
  s_waitcnt lgkmcnt(10)
  v_lshlrev_b32 v199, 6, v199
  s_waitcnt lgkmcnt(9)
  v_lshlrev_b32 v203, 6, v203
  s_waitcnt lgkmcnt(8)
  v_lshlrev_b32 v207, 6, v207
  s_waitcnt lgkmcnt(7)
  v_lshlrev_b32 v252, 6, v252
  s_waitcnt lgkmcnt(6)
  v_lshlrev_b32 v253, 6, v253
  s_waitcnt lgkmcnt(5)
  v_lshlrev_b32 v254, 6, v254
  s_waitcnt lgkmcnt(4)
  v_lshlrev_b32 v255, 6, v255
  s_waitcnt lgkmcnt(3)
  v_lshlrev_b32 v92, 6, v92
  s_waitcnt lgkmcnt(2)
  v_lshlrev_b32 v93, 6, v93
  s_waitcnt lgkmcnt(1)
  v_lshlrev_b32 v94, 6, v94
  s_waitcnt lgkmcnt(0)
  v_lshlrev_b32 v95, 6, v95
  s_waitcnt vmcnt(22)
  s_cmp_lg_u32 s40, 0
  s_cbranch_scc1 L_ready
  s_waitcnt vmcnt(6)
  v_cmp_le_u32 vcc, 56, v112
  s_nop 0
  s_cbranch_vccnz L_ready
  s_mov_b32 s45, 0
L_spin:
  buffer_load_dword v112, v120, s[68:71], 0 offen sc1
  s_add_u32 s45, s45, 1
  s_waitcnt vmcnt(0)
  v_cmp_le_u32 vcc, 56, v112
  s_nop 0
  s_cbranch_vccnz L_ready
  s_sleep 8
  s_cmp_lt_u32 s45, 0x20000
  s_cbranch_scc1 L_spin
L_ready:
  s_barrier
  buffer_load_dwordx4 v[128:131], v4, s[32:35], s43 offen offset:0 sc1
  buffer_load_dwordx4 v[132:135], v4, s[32:35], s43 offen offset:1024 sc1
  buffer_load_dwordx4 v[136:139], v4, s[32:35], s43 offen offset:2048 sc1
  buffer_load_dwordx4 v[140:143], v4, s[32:35], s43 offen offset:3072 sc1
  s_sub_u32 s43, s43, 196608
  s_add_u32 m0, s41, 133120
  s_nop 0
  buffer_load_dwordx4 v4, s[32:35], s73 offen sc1 lds
  s_add_u32 s73, s73, 4096
  s_add_u32 m0, s41, 137216
  s_nop 0
  buffer_load_dwordx4 v4, s[32:35], s73 offen sc1 lds
  s_add_u32 s73, s73, 4096
  s_add_u32 m0, s41, 141312
  s_nop 0
  buffer_load_dwordx4 v4, s[32:35], s73 offen sc1 lds
  s_add_u32 s73, s73, 4096
  buffer_load_dwordx4 v[144:147], v4, s[32:35], s62 offen offset:0 sc1
  buffer_load_dwordx4 v[148:151], v4, s[32:35], s62 offen offset:1024 sc1
  buffer_load_dwordx4 v[152:155], v4, s[32:35], s62 offen offset:2048 sc1
  buffer_load_dwordx4 v[156:159], v4, s[32:35], s62 offen offset:3072 sc1
  s_sub_u32 s62, s62, 196608
  ds_read_b128 v[48:51], v33 offset:0
  ds_read_b128 v[52:55], v33 offset:1024
  ds_read_b128 v[56:59], v33 offset:2048
  ds_read_b128 v[60:63], v33 offset:3072
  s_add_u32 m0, s44, 66560
  v_add_u32_dpp v2, v193, v1 quad_perm:[0,0,0,0] row_mask:0xf bank_mask:0xf
  buffer_load_dwordx4 v2, s[28:31], 0 offen lds
  s_add_u32 m0, s44, 67600
  v_add_u32_dpp v3, v193, v1 quad_perm:[1,1,1,1] row_mask:0xf bank_mask:0xf
  buffer_load_dwordx4 v3, s[28:31], 0 offen lds
  s_add_u32 m0, s44, 68640
  v_add_u32_dpp v2, v193, v1 quad_perm:[2,2,2,2] row_mask:0xf bank_mask:0xf
  buffer_load_dwordx4 v2, s[28:31], 0 offen lds
  s_add_u32 m0, s44, 69680
  v_add_u32_dpp v3, v193, v1 quad_perm:[3,3,3,3] row_mask:0xf bank_mask:0xf
  buffer_load_dwordx4 v3, s[28:31], 0 offen lds
  s_waitcnt vmcnt(15)
  v_lshlrev_b32 v121, 16, v121
  v_lshlrev_b32 v160, 16, v96
  v_and_b32 v176, 0xffff0000, v96
  v_lshlrev_b32 v164, 16, v96
  v_and_b32 v180, 0xffff0000, v96
  v_lshlrev_b32 v168, 16, v96
  v_and_b32 v184, 0xffff0000, v96
  v_lshlrev_b32 v172, 16, v96
  v_and_b32 v188, 0xffff0000, v96
  v_lshlrev_b32 v161, 16, v97
  v_and_b32 v177, 0xffff0000, v97
  v_lshlrev_b32 v165, 16, v97
  v_and_b32 v181, 0xffff0000, v97
  v_lshlrev_b32 v169, 16, v97
  v_and_b32 v185, 0xffff0000, v97
  v_lshlrev_b32 v173, 16, v97
  v_and_b32 v189, 0xffff0000, v97
  v_lshlrev_b32 v162, 16, v98
  v_and_b32 v178, 0xffff0000, v98
  v_lshlrev_b32 v166, 16, v98
  v_and_b32 v182, 0xffff0000, v98
  v_lshlrev_b32 v170, 16, v98
  v_and_b32 v186, 0xffff0000, v98
  v_lshlrev_b32 v174, 16, v98
  v_and_b32 v190, 0xffff0000, v98
  v_lshlrev_b32 v163, 16, v99
  v_and_b32 v179, 0xffff0000, v99
  v_lshlrev_b32 v167, 16, v99
  v_and_b32 v183, 0xffff0000, v99
  v_lshlrev_b32 v171, 16, v99
  v_and_b32 v187, 0xffff0000, v99
  v_lshlrev_b32 v175, 16, v99
  v_and_b32 v191, 0xffff0000, v99
  v_readfirstlane_b32 s59, v121
  v_xad_u32 v5, v7, 0, v11
  ds_read_b128 v[96:99], v5 offset:0
  ds_read_b128 v[100:103], v5 offset:4096
  ds_read_b128 v[104:107], v5 offset:8192
  ds_read_b128 v[108:111], v5 offset:12288
  v_xad_u32 v5, v7, 48, v11
  s_waitcnt vmcnt(14) lgkmcnt(2)
  v_mfma_f32_16x16x32_bf16 v[160:163], v[128:131], v[96:99], v[160:163]
  ds_read_b128 v[112:115], v5 offset:256
  ds_read_b128 v[116:119], v5 offset:4352
  v_mfma_f32_16x16x32_bf16 v[164:167], v[128:131], v[100:103], v[164:167]
  s_waitcnt lgkmcnt(2)
  ds_read_b128 v[120:123], v5 offset:8448
  ds_read_b128 v[124:127], v5 offset:12544
  v_mfma_f32_16x16x32_bf16 v[168:171], v[128:131], v[104:107], v[168:171]
  s_add_u32 m0, s44, 70720
  v_add_u32_dpp v2, v197, v6 quad_perm:[0,0,0,0] row_mask:0xf bank_mask:0xf
  v_mfma_f32_16x16x32_bf16 v[172:175], v[128:131], v[108:111], v[172:175]
  s_waitcnt vmcnt(13)
  buffer_load_dwordx4 v2, s[28:31], 0 offen lds
  buffer_load_dwordx4 v[128:131], v4, s[32:35], s43 offen offset:0 sc1
  v_mfma_f32_16x16x32_bf16 v[188:191], v[132:135], v[108:111], v[188:191]
  v_xad_u32 v5, v7, 32, v11
  v_mfma_f32_16x16x32_bf16 v[184:187], v[132:135], v[104:107], v[184:187]
  v_mfma_f32_16x16x32_bf16 v[180:183], v[132:135], v[100:103], v[180:183]
  v_mfma_f32_16x16x32_bf16 v[176:179], v[132:135], v[96:99], v[176:179]
  s_waitcnt vmcnt(14) lgkmcnt(2)
  buffer_load_dwordx4 v[132:135], v4, s[32:35], s43 offen offset:1024 sc1
  v_mfma_f32_16x16x32_bf16 v[160:163], v[136:139], v[112:115], v[160:163]
  ds_read_b128 v[96:99], v5 offset:512
  ds_read_b128 v[100:103], v5 offset:4608
  v_mfma_f32_16x16x32_bf16 v[164:167], v[136:139], v[116:119], v[164:167]
  s_waitcnt lgkmcnt(2)
  ds_read_b128 v[104:107], v5 offset:8704
  ds_read_b128 v[108:111], v5 offset:12800
  v_mfma_f32_16x16x32_bf16 v[168:171], v[136:139], v[120:123], v[168:171]
  v_mfma_f32_16x16x32_bf16 v[172:175], v[136:139], v[124:127], v[172:175]
  s_waitcnt vmcnt(14)
  buffer_load_dwordx4 v[136:139], v4, s[32:35], s43 offen offset:2048 sc1
  v_add_u32_dpp v3, v197, v6 quad_perm:[1,1,1,1] row_mask:0xf bank_mask:0xf
  v_mfma_f32_16x16x32_bf16 v[188:191], v[140:143], v[124:127], v[188:191]
  s_add_u32 m0, s44, 71760
  v_xad_u32 v5, v7, 16, v11
  v_mfma_f32_16x16x32_bf16 v[184:187], v[140:143], v[120:123], v[184:187]
  buffer_load_dwordx4 v3, s[28:31], 0 offen lds
  v_mfma_f32_16x16x32_bf16 v[180:183], v[140:143], v[116:119], v[180:183]
  v_mfma_f32_16x16x32_bf16 v[176:179], v[140:143], v[112:115], v[176:179]
  s_waitcnt vmcnt(12) lgkmcnt(2)
  buffer_load_dwordx4 v[140:143], v4, s[32:35], s43 offen offset:3072 sc1
  v_mfma_f32_16x16x32_bf16 v[160:163], v[144:147], v[96:99], v[160:163]
  s_add_u32 s43, s43, 8192
  ds_read_b128 v[112:115], v5 offset:768
  ds_read_b128 v[116:119], v5 offset:4864
  v_mfma_f32_16x16x32_bf16 v[164:167], v[144:147], v[100:103], v[164:167]
  s_waitcnt lgkmcnt(2)
  ds_read_b128 v[120:123], v5 offset:8960
  ds_read_b128 v[124:127], v5 offset:13056
  v_mfma_f32_16x16x32_bf16 v[168:171], v[144:147], v[104:107], v[168:171]
  v_mfma_f32_16x16x32_bf16 v[172:175], v[144:147], v[108:111], v[172:175]
  s_waitcnt vmcnt(12)
  buffer_load_dwordx4 v[144:147], v4, s[32:35], s62 offen offset:0 sc1
  v_mfma_f32_16x16x32_bf16 v[188:191], v[148:151], v[108:111], v[188:191]
  v_and_b32 v11, 15, v0
  v_add_u32 v5, 4, v11
  v_mfma_f32_16x16x32_bf16 v[184:187], v[148:151], v[104:107], v[184:187]
  v_and_b32 v5, 8, v5
  v_lshlrev_b32 v5, 1, v5
  v_mfma_f32_16x16x32_bf16 v[180:183], v[148:151], v[100:103], v[180:183]
  s_add_u32 m0, s44, 72800
  v_xor_b32 v7, v7, v5
  v_mul_u32_u24 v11, 1040, v11
  v_mfma_f32_16x16x32_bf16 v[176:179], v[148:151], v[96:99], v[176:179]
  s_waitcnt vmcnt(12) lgkmcnt(0)
  s_barrier
  buffer_load_dwordx4 v[148:151], v4, s[32:35], s62 offen offset:1024 sc1
  ds_read_b128 v[12:15], v10 offset:0
  v_xad_u32 v5, v7, 0, v11
  v_mfma_f32_16x16x32_bf16 v[160:163], v[152:155], v[112:115], v[160:163]
  ds_read_b128 v[88:91], v10 offset:1024
  ds_read_b128 a[0:3], v8 offset:0
  v_mfma_f32_16x16x32_bf16 v[164:167], v[152:155], v[116:119], v[164:167]
  ds_read_b128 v[64:67], v10 offset:3072
  ds_read_b128 v[68:71], v10 offset:4096
  v_mfma_f32_16x16x32_bf16 v[168:171], v[152:155], v[120:123], v[168:171]
  ds_read_b128 v[72:75], v10 offset:5120
  ds_read_b128 v[76:79], v10 offset:6144
  v_mfma_f32_16x16x32_bf16 v[172:175], v[152:155], v[124:127], v[172:175]
  s_waitcnt vmcnt(12)
  buffer_load_dwordx4 v[152:155], v4, s[32:35], s62 offen offset:2048 sc1
  ds_read_b128 v[80:83], v10 offset:7168
  v_add_u32_dpp v2, v197, v6 quad_perm:[2,2,2,2] row_mask:0xf bank_mask:0xf
  v_mfma_f32_16x16x32_bf16 v[188:191], v[156:159], v[124:127], v[188:191]
  ds_read_b128 v[84:87], v10 offset:8192
  ds_read_b128 v[96:99], v5 offset:0
  ds_read_b128 v[100:103], v5 offset:16640
  ds_read_b128 v[104:107], v5 offset:33280
  ds_read_b128 v[108:111], v5 offset:49920
  buffer_load_dwordx4 v2, s[28:31], 0 offen lds
  v_mfma_f32_16x16x32_bf16 v[184:187], v[156:159], v[120:123], v[184:187]
  v_mfma_f32_16x16x32_bf16 v[180:183], v[156:159], v[116:119], v[180:183]
  v_mfma_f32_16x16x32_bf16 v[176:179], v[156:159], v[112:115], v[176:179]
  s_waitcnt vmcnt(8) lgkmcnt(2)
  buffer_load_dwordx4 v[156:159], v4, s[32:35], s62 offen offset:3072 sc1
  v_mfma_f32_16x16x32_bf16 v[160:163], v[128:131], v[96:99], v[160:163]
  s_add_u32 s62, s62, 8192
  ds_read_b128 v[112:115], v5 offset:64
  ds_read_b128 v[116:119], v5 offset:16704
  v_mfma_f32_16x16x32_bf16 v[164:167], v[128:131], v[100:103], v[164:167]
  s_waitcnt lgkmcnt(2)
  ds_read_b128 v[120:123], v5 offset:33344
  ds_read_b128 v[124:127], v5 offset:49984
  v_mfma_f32_16x16x32_bf16 v[168:171], v[128:131], v[104:107], v[168:171]
  s_add_u32 m0, s44, 73840
  v_add_u32_dpp v3, v197, v6 quad_perm:[3,3,3,3] row_mask:0xf bank_mask:0xf
  v_mfma_f32_16x16x32_bf16 v[172:175], v[128:131], v[108:111], v[172:175]
  s_waitcnt vmcnt(8)
  buffer_load_dwordx4 v3, s[28:31], 0 offen lds
  buffer_load_dwordx4 v[128:131], v4, s[32:35], s43 offen offset:0 sc1
  v_mfma_f32_16x16x32_bf16 v[188:191], v[132:135], v[108:111], v[188:191]
  v_mfma_f32_16x16x32_bf16 v[184:187], v[132:135], v[104:107], v[184:187]
  v_mfma_f32_16x16x32_bf16 v[180:183], v[132:135], v[100:103], v[180:183]
  v_mfma_f32_16x16x32_bf16 v[176:179], v[132:135], v[96:99], v[176:179]
  s_waitcnt vmcnt(9) lgkmcnt(2)
  buffer_load_dwordx4 v[132:135], v4, s[32:35], s43 offen offset:1024 sc1
  v_mfma_f32_16x16x32_bf16 v[160:163], v[136:139], v[112:115], v[160:163]
  ds_read_b128 v[96:99], v5 offset:128
  ds_read_b128 v[100:103], v5 offset:16768
  v_mfma_f32_16x16x32_bf16 v[164:167], v[136:139], v[116:119], v[164:167]
  ds_read_b128 v[104:107], v5 offset:33408
  ds_read_b128 v[108:111], v5 offset:50048
  v_mfma_f32_16x16x32_bf16 v[36:39], a[0:3], a[0:3], 0
  s_waitcnt lgkmcnt(4)
  ds_read_b128 a[4:7], v8 offset:1040
  v_mfma_f32_16x16x32_bf16 v[168:171], v[136:139], v[120:123], v[168:171]
  v_mfma_f32_16x16x32_bf16 v[172:175], v[136:139], v[124:127], v[172:175]
  buffer_load_dwordx4 v[136:139], v4, s[32:35], s43 offen offset:2048 sc1
  v_mfma_f32_16x16x32_bf16 v[40:43], v[48:51], a[0:3], 0
  s_waitcnt vmcnt(9)
  v_mfma_f32_16x16x32_bf16 v[188:191], v[140:143], v[124:127], v[188:191]
  s_add_u32 m0, s44, 74880
  v_add_u32_dpp v2, v201, v6 quad_perm:[0,0,0,0] row_mask:0xf bank_mask:0xf
  v_fmac_f32 v16, v36, v64
  v_mfma_f32_16x16x32_bf16 v[184:187], v[140:143], v[120:123], v[184:187]
  buffer_load_dwordx4 v2, s[28:31], 0 offen lds
  v_fmac_f32 v16, v37, v65
  v_mfma_f32_16x16x32_bf16 v[44:47], v[48:51], v[48:51], 0
  v_fmac_f32 v16, v38, v66
  v_fmac_f32 v16, v39, v67
  v_mfma_f32_16x16x32_bf16 v[180:183], v[140:143], v[116:119], v[180:183]
  v_fmac_f32 v16, v40, v88
  v_mfma_f32_16x16x32_bf16 v[176:179], v[140:143], v[112:115], v[176:179]
  s_waitcnt vmcnt(9) lgkmcnt(3)
  buffer_load_dwordx4 v[140:143], v4, s[32:35], s43 offen offset:3072 sc1
  v_mfma_f32_16x16x32_bf16 v[160:163], v[144:147], v[96:99], v[160:163]
  s_waitcnt lgkmcnt(0)
  ds_read_b128 v[112:115], v5 offset:192
  ds_read_b128 v[116:119], v5 offset:16832
  v_mfma_f32_16x16x32_bf16 v[36:39], a[4:7], a[4:7], 0
  s_add_u32 s43, s43, 8192
  ds_read_b128 v[120:123], v5 offset:33472
  ds_read_b128 v[124:127], v5 offset:50112
  v_mfma_f32_16x16x32_bf16 v[164:167], v[144:147], v[100:103], v[164:167]
  ds_read_b128 a[8:11], v8 offset:2080
  v_fmac_f32 v16, v44, v12
  v_mfma_f32_16x16x32_bf16 v[168:171], v[144:147], v[104:107], v[168:171]
  v_fmac_f32 v17, v45, v13
  v_fmac_f32 v18, v46, v14
  v_mfma_f32_16x16x32_bf16 v[172:175], v[144:147], v[108:111], v[172:175]
  s_waitcnt vmcnt(9)
  buffer_load_dwordx4 v[144:147], v4, s[32:35], s62 offen offset:0 sc1
  v_fmac_f32 v19, v47, v15
  v_fmac_f32 v17, v36, v64
  v_mfma_f32_16x16x32_bf16 v[188:191], v[148:151], v[108:111], v[188:191]
  v_xad_u32 v5, v7, 48, v11
  v_fmac_f32 v17, v37, v65
  v_mfma_f32_16x16x32_bf16 v[40:43], v[48:51], a[4:7], 0
  v_fmac_f32 v17, v38, v66
  v_fmac_f32 v17, v39, v67
  v_mfma_f32_16x16x32_bf16 v[184:187], v[148:151], v[104:107], v[184:187]
  v_mfma_f32_16x16x32_bf16 v[180:183], v[148:151], v[100:103], v[180:183]
  v_mfma_f32_16x16x32_bf16 v[176:179], v[148:151], v[96:99], v[176:179]
  s_waitcnt lgkmcnt(0)
  buffer_load_dwordx4 v[148:151], v4, s[32:35], s62 offen offset:1024 sc1
  v_add_u32_dpp v3, v201, v6 quad_perm:[1,1,1,1] row_mask:0xf bank_mask:0xf
  v_fmac_f32 v17, v41, v88
  v_mfma_f32_16x16x32_bf16 v[44:47], a[8:11], a[8:11], 0
  s_waitcnt vmcnt(10)
  ds_read_b128 a[12:15], v8 offset:3120
  s_add_u32 m0, s44, 75920
  v_mfma_f32_16x16x32_bf16 v[160:163], v[152:155], v[112:115], v[160:163]
  buffer_load_dwordx4 v3, s[28:31], 0 offen lds
  ds_read_b128 v[96:99], v5 offset:256
  ds_read_b128 v[100:103], v5 offset:16896
  v_mfma_f32_16x16x32_bf16 v[164:167], v[152:155], v[116:119], v[164:167]
  ds_read_b128 v[104:107], v5 offset:33536
  ds_read_b128 v[108:111], v5 offset:50176
  v_mfma_f32_16x16x32_bf16 v[168:171], v[152:155], v[120:123], v[168:171]
  v_fmac_f32 v18, v44, v64
  v_fmac_f32 v18, v45, v65
  v_mfma_f32_16x16x32_bf16 v[172:175], v[152:155], v[124:127], v[172:175]
  buffer_load_dwordx4 v[152:155], v4, s[32:35], s62 offen offset:2048 sc1
  v_fmac_f32 v18, v46, v66
  v_fmac_f32 v18, v47, v67
  v_mfma_f32_16x16x32_bf16 v[36:39], v[48:51], a[8:11], 0
  s_waitcnt vmcnt(10)
  v_mfma_f32_16x16x32_bf16 v[188:191], v[156:159], v[124:127], v[188:191]
  v_mfma_f32_16x16x32_bf16 v[184:187], v[156:159], v[120:123], v[184:187]
  s_waitcnt lgkmcnt(4)
  v_mfma_f32_16x16x32_bf16 v[40:43], a[12:15], a[12:15], 0
  ds_read_b128 a[64:67], v9 offset:0
  v_mfma_f32_16x16x32_bf16 v[180:183], v[156:159], v[116:119], v[180:183]
  v_mfma_f32_16x16x32_bf16 v[176:179], v[156:159], v[112:115], v[176:179]
  buffer_load_dwordx4 v[156:159], v4, s[32:35], s62 offen offset:3072 sc1
  v_fmac_f32 v18, v38, v88
  v_mfma_f32_16x16x32_bf16 v[44:47], v[48:51], a[12:15], 0
  s_waitcnt vmcnt(9) lgkmcnt(3)
  v_mfma_f32_16x16x32_bf16 v[160:163], v[128:131], v[96:99], v[160:163]
  s_waitcnt lgkmcnt(0)
  ds_read_b128 v[112:115], v5 offset:320
  ds_read_b128 v[116:119], v5 offset:16960
  v_mfma_f32_16x16x32_bf16 v[36:39], a[0:3], a[64:67], 0
  s_add_u32 s62, s62, 8192
  ds_read_b128 v[120:123], v5 offset:33600
  ds_read_b128 v[124:127], v5 offset:50240
  v_mfma_f32_16x16x32_bf16 v[164:167], v[128:131], v[100:103], v[164:167]
  v_xor_b32 v8, 16, v8
  ds_read_b128 a[16:19], v8 offset:4160
  v_fmac_f32 v19, v40, v64
  v_mfma_f32_16x16x32_bf16 v[168:171], v[128:131], v[104:107], v[168:171]
  s_add_u32 m0, s44, 76960
  v_add_u32_dpp v2, v201, v6 quad_perm:[2,2,2,2] row_mask:0xf bank_mask:0xf
  v_fmac_f32 v19, v41, v65
  v_fmac_f32 v19, v42, v66
  v_fmac_f32 v19, v43, v67
  v_mfma_f32_16x16x32_bf16 v[40:43], a[64:67], a[64:67], 0
  buffer_load_dwordx4 v2, s[28:31], 0 offen lds
  v_fmac_f32 v19, v47, v88
  v_mfma_f32_16x16x32_bf16 v[172:175], v[128:131], v[108:111], v[172:175]
  buffer_load_dwordx4 v[128:131], v4, s[32:35], s43 offen offset:0 sc1
  v_fmac_f32 v16, v36, v68
  v_fmac_f32 v16, v37, v69
  v_mfma_f32_16x16x32_bf16 v[44:47], v[48:51], a[64:67], 0
  s_waitcnt vmcnt(10)
  v_fmac_f32 v16, v38, v70
  v_fmac_f32 v16, v39, v71
  v_mfma_f32_16x16x32_bf16 v[188:191], v[132:135], v[108:111], v[188:191]
  s_waitcnt lgkmcnt(0)
  v_fmac_f32 v16, v40, v72
  v_fmac_f32 v16, v41, v73
  v_mfma_f32_16x16x32_bf16 v[36:39], a[16:19], a[16:19], 0
  ds_read_b128 a[68:71], v9 offset:1040
  v_fmac_f32 v16, v42, v74
  v_mfma_f32_16x16x32_bf16 v[184:187], v[132:135], v[104:107], v[184:187]
  v_fmac_f32 v16, v43, v75
  v_fmac_f32 v16, v44, v89
  v_mfma_f32_16x16x32_bf16 v[180:183], v[132:135], v[100:103], v[180:183]
  v_mfma_f32_16x16x32_bf16 v[40:43], v[52:55], a[16:19], 0
  v_mfma_f32_16x16x32_bf16 v[176:179], v[132:135], v[96:99], v[176:179]
  buffer_load_dwordx4 v[132:135], v4, s[32:35], s43 offen offset:1024 sc1
  v_fmac_f32 v20, v36, v64
  v_fmac_f32 v20, v37, v65
  v_mfma_f32_16x16x32_bf16 v[44:47], v[52:55], v[52:55], 0
  s_waitcnt vmcnt(10)
  v_fmac_f32 v20, v38, v66
  v_fmac_f32 v20, v39, v67
  v_mfma_f32_16x16x32_bf16 v[160:163], v[136:139], v[112:115], v[160:163]
  s_waitcnt lgkmcnt(0)
  ds_read_b128 v[96:99], v5 offset:384
  ds_read_b128 v[100:103], v5 offset:17024
  v_mfma_f32_16x16x32_bf16 v[36:39], a[4:7], a[68:71], 0
  ds_read_b128 v[104:107], v5 offset:33664
  ds_read_b128 v[108:111], v5 offset:50304
  v_mfma_f32_16x16x32_bf16 v[164:167], v[136:139], v[116:119], v[164:167]
  ds_read_b128 a[20:23], v8 offset:5200
  v_fmac_f32 v20, v40, v88
  v_mfma_f32_16x16x32_bf16 v[40:43], a[68:71], a[68:71], 0
  v_fmac_f32 v20, v44, v12
  v_fmac_f32 v21, v45, v13
  v_mfma_f32_16x16x32_bf16 v[168:171], v[136:139], v[120:123], v[168:171]
  v_fmac_f32 v22, v46, v14
  v_fmac_f32 v23, v47, v15
  v_mfma_f32_16x16x32_bf16 v[44:47], v[48:51], a[68:71], 0
  v_fmac_f32 v17, v36, v68
  v_fmac_f32 v17, v37, v69
  v_mfma_f32_16x16x32_bf16 v[172:175], v[136:139], v[124:127], v[172:175]
  s_waitcnt vmcnt(8)
  buffer_load_dwordx4 v[136:139], v4, s[32:35], s43 offen offset:2048 sc1
  v_fmac_f32 v17, v38, v70
  v_fmac_f32 v17, v39, v71
  v_mfma_f32_16x16x32_bf16 v[188:191], v[140:143], v[124:127], v[188:191]
  s_waitcnt lgkmcnt(0)
  v_fmac_f32 v17, v40, v72
  v_fmac_f32 v17, v41, v73
  v_mfma_f32_16x16x32_bf16 v[36:39], a[20:23], a[20:23], 0
  ds_read_b128 a[72:75], v9 offset:2080
  v_fmac_f32 v17, v42, v74
  v_mfma_f32_16x16x32_bf16 v[184:187], v[140:143], v[120:123], v[184:187]
  s_add_u32 m0, s44, 78000
  v_add_u32_dpp v3, v201, v6 quad_perm:[3,3,3,3] row_mask:0xf bank_mask:0xf
  v_fmac_f32 v17, v43, v75
  v_mfma_f32_16x16x32_bf16 v[180:183], v[140:143], v[116:119], v[180:183]
  buffer_load_dwordx4 v3, s[28:31], 0 offen lds
  v_fmac_f32 v17, v45, v89
  v_mfma_f32_16x16x32_bf16 v[40:43], v[52:55], a[20:23], 0
  v_fmac_f32 v21, v36, v64
  v_fmac_f32 v21, v37, v65
  v_mfma_f32_16x16x32_bf16 v[176:179], v[140:143], v[112:115], v[176:179]
  s_waitcnt vmcnt(9)
  buffer_load_dwordx4 v[140:143], v4, s[32:35], s43 offen offset:3072 sc1
  v_fmac_f32 v21, v38, v66
  v_fmac_f32 v21, v39, v67
  v_mfma_f32_16x16x32_bf16 v[160:163], v[144:147], v[96:99], v[160:163]
  s_waitcnt lgkmcnt(0)
  ds_read_b128 v[112:115], v5 offset:448
  ds_read_b128 v[116:119], v5 offset:17088
  v_mfma_f32_16x16x32_bf16 v[44:47], a[8:11], a[72:75], 0
  s_add_u32 s43, s43, 8192
  ds_read_b128 v[120:123], v5 offset:33728
  ds_read_b128 v[124:127], v5 offset:50368
  v_mfma_f32_16x16x32_bf16 v[164:167], v[144:147], v[100:103], v[164:167]
  ds_read_b128 a[24:27], v8 offset:6240
  v_fmac_f32 v21, v41, v88
  v_mfma_f32_16x16x32_bf16 v[36:39], a[72:75], a[72:75], 0
  v_mfma_f32_16x16x32_bf16 v[40:43], v[48:51], a[72:75], 0
  v_fmac_f32 v18, v44, v68
  v_fmac_f32 v18, v45, v69
  v_mfma_f32_16x16x32_bf16 v[168:171], v[144:147], v[104:107], v[168:171]
  v_fmac_f32 v18, v46, v70
  v_fmac_f32 v18, v47, v71
  v_mfma_f32_16x16x32_bf16 v[172:175], v[144:147], v[108:111], v[172:175]
  s_waitcnt lgkmcnt(0)
  buffer_load_dwordx4 v[144:147], v4, s[32:35], s62 offen offset:0 sc1
  v_fmac_f32 v18, v36, v72
  v_fmac_f32 v18, v37, v73
  v_mfma_f32_16x16x32_bf16 v[44:47], a[24:27], a[24:27], 0
  s_waitcnt vmcnt(10)
  ds_read_b128 a[76:79], v9 offset:3120
  v_fmac_f32 v18, v38, v74
  v_mfma_f32_16x16x32_bf16 v[188:191], v[148:151], v[108:111], v[188:191]
  v_xad_u32 v5, v7, 32, v11
  v_fmac_f32 v18, v39, v75
  v_mfma_f32_16x16x32_bf16 v[184:187], v[148:151], v[104:107], v[184:187]
  v_fmac_f32 v18, v42, v89
  v_fmac_f32 v22, v44, v64
  v_mfma_f32_16x16x32_bf16 v[180:183], v[148:151], v[100:103], v[180:183]
  v_fmac_f32 v22, v45, v65
  v_fmac_f32 v22, v46, v66
  v_mfma_f32_16x16x32_bf16 v[36:39], v[52:55], a[24:27], 0
  v_fmac_f32 v22, v47, v67
  v_mfma_f32_16x16x32_bf16 v[176:179], v[148:151], v[96:99], v[176:179]
  s_waitcnt vmcnt(8)
  buffer_load_dwordx4 v[148:151], v4, s[32:35], s62 offen offset:1024 sc1
  v_mfma_f32_16x16x32_bf16 v[160:163], v[152:155], v[112:115], v[160:163]
  s_waitcnt lgkmcnt(0)
  ds_read_b128 v[96:99], v5 offset:512
  ds_read_b128 v[100:103], v5 offset:17152
  v_mfma_f32_16x16x32_bf16 v[40:43], a[12:15], a[76:79], 0
  s_add_u32 m0, s44, 79040
  ds_read_b128 v[104:107], v5 offset:33792
  ds_read_b128 v[108:111], v5 offset:50432
  v_mfma_f32_16x16x32_bf16 v[44:47], a[76:79], a[76:79], 0
  ds_read_b128 a[28:31], v8 offset:7280
  v_add_u32_dpp v2, v205, v1 quad_perm:[0,0,0,0] row_mask:0xf bank_mask:0xf
  v_fmac_f32 v22, v38, v88
  v_mfma_f32_16x16x32_bf16 v[36:39], v[48:51], a[76:79], 0
  buffer_load_dwordx4 v2, s[28:31], 0 offen lds
  v_fmac_f32 v19, v40, v68
  v_mfma_f32_16x16x32_bf16 v[164:167], v[152:155], v[116:119], v[164:167]
  v_fmac_f32 v19, v41, v69
  v_fmac_f32 v19, v42, v70
  v_mfma_f32_16x16x32_bf16 v[168:171], v[152:155], v[120:123], v[168:171]
  s_waitcnt lgkmcnt(0)
  v_fmac_f32 v19, v43, v71
  v_fmac_f32 v19, v44, v72
  v_mfma_f32_16x16x32_bf16 v[40:43], a[28:31], a[28:31], 0
  ds_read_b128 a[32:35], v8 offset:8320
  v_fmac_f32 v19, v45, v73
  v_mfma_f32_16x16x32_bf16 v[172:175], v[152:155], v[124:127], v[172:175]
  s_waitcnt vmcnt(9)
  buffer_load_dwordx4 v[152:155], v4, s[32:35], s62 offen offset:2048 sc1
  v_fmac_f32 v19, v46, v74
  v_fmac_f32 v19, v47, v75
  v_mfma_f32_16x16x32_bf16 v[188:191], v[156:159], v[124:127], v[188:191]
  v_fmac_f32 v19, v39, v89
  v_fmac_f32 v23, v40, v64
  v_mfma_f32_16x16x32_bf16 v[184:187], v[156:159], v[120:123], v[184:187]
  v_fmac_f32 v23, v41, v65
  v_fmac_f32 v23, v42, v66
  v_mfma_f32_16x16x32_bf16 v[180:183], v[156:159], v[116:119], v[180:183]
  v_fmac_f32 v23, v43, v67
  v_mfma_f32_16x16x32_bf16 v[44:47], v[52:55], a[28:31], 0
  v_mfma_f32_16x16x32_bf16 v[176:179], v[156:159], v[112:115], v[176:179]
  s_waitcnt vmcnt(8)
  buffer_load_dwordx4 v[156:159], v4, s[32:35], s62 offen offset:3072 sc1
  v_mfma_f32_16x16x32_bf16 v[160:163], v[128:131], v[96:99], v[160:163]
  s_waitcnt lgkmcnt(0)
  ds_read_b128 v[112:115], v5 offset:576
  ds_read_b128 v[116:119], v5 offset:17216
  v_mfma_f32_16x16x32_bf16 v[36:39], a[32:35], a[32:35], 0
  s_add_u32 s62, s62, 8192
  ds_read_b128 v[120:123], v5 offset:33856
  ds_read_b128 v[124:127], v5 offset:50496
  v_mfma_f32_16x16x32_bf16 v[40:43], v[56:59], a[32:35], 0
  v_xor_b32 v9, 16, v9
  ds_read_b128 a[80:83], v9 offset:4160
  v_fmac_f32 v23, v47, v88
  v_mfma_f32_16x16x32_bf16 v[44:47], v[56:59], v[56:59], 0
  v_fmac_f32 v24, v36, v64
  v_fmac_f32 v24, v37, v65
  v_mfma_f32_16x16x32_bf16 v[164:167], v[128:131], v[100:103], v[164:167]
  s_waitcnt lgkmcnt(0)
  v_fmac_f32 v24, v38, v66
  v_fmac_f32 v24, v39, v67
  v_mfma_f32_16x16x32_bf16 v[36:39], a[16:19], a[80:83], 0
  ds_read_b128 a[36:39], v8 offset:9360
  v_fmac_f32 v24, v40, v88
  v_mfma_f32_16x16x32_bf16 v[168:171], v[128:131], v[104:107], v[168:171]
  v_fmac_f32 v24, v44, v12
  v_fmac_f32 v25, v45, v13
  v_mfma_f32_16x16x32_bf16 v[172:175], v[128:131], v[108:111], v[172:175]
  s_add_u32 m0, s44, 80080
  buffer_load_dwordx4 v[128:131], v4, s[32:35], s43 offen offset:0 sc1
  v_add_u32_dpp v3, v205, v1 quad_perm:[1,1,1,1] row_mask:0xf bank_mask:0xf
  v_fmac_f32 v26, v46, v14
  v_mfma_f32_16x16x32_bf16 v[40:43], a[80:83], a[80:83], 0
  s_waitcnt vmcnt(9)
  buffer_load_dwordx4 v3, s[28:31], 0 offen lds
  v_fmac_f32 v27, v47, v15
  v_mfma_f32_16x16x32_bf16 v[188:191], v[132:135], v[108:111], v[188:191]
  v_fmac_f32 v20, v36, v68
  v_fmac_f32 v20, v37, v69
  v_mfma_f32_16x16x32_bf16 v[184:187], v[132:135], v[104:107], v[184:187]
  v_fmac_f32 v20, v38, v70
  v_fmac_f32 v20, v39, v71
  v_mfma_f32_16x16x32_bf16 v[44:47], v[52:55], a[80:83], 0
  v_fmac_f32 v20, v40, v72
  v_fmac_f32 v20, v41, v73
  v_mfma_f32_16x16x32_bf16 v[180:183], v[132:135], v[100:103], v[180:183]
  v_fmac_f32 v20, v42, v74
  v_fmac_f32 v20, v43, v75
  v_mfma_f32_16x16x32_bf16 v[176:179], v[132:135], v[96:99], v[176:179]
  s_waitcnt lgkmcnt(0)
  buffer_load_dwordx4 v[132:135], v4, s[32:35], s43 offen offset:1024 sc1
  v_fmac_f32 v20, v44, v89
  v_mfma_f32_16x16x32_bf16 v[36:39], a[36:39], a[36:39], 0
  ds_read_b128 a[84:87], v9 offset:5200
  v_mfma_f32_16x16x32_bf16 v[40:43], v[56:59], a[36:39], 0
  s_waitcnt vmcnt(10)
  v_mfma_f32_16x16x32_bf16 v[160:163], v[136:139], v[112:115], v[160:163]
  ds_read_b128 v[96:99], v5 offset:640
  ds_read_b128 v[100:103], v5 offset:17280
  v_mfma_f32_16x16x32_bf16 v[164:167], v[136:139], v[116:119], v[164:167]
  s_waitcnt lgkmcnt(2)
  ds_read_b128 v[104:107], v5 offset:33920
  ds_read_b128 v[108:111], v5 offset:50560
  v_mfma_f32_16x16x32_bf16 v[44:47], a[20:23], a[84:87], 0
  ds_read_b128 a[40:43], v8 offset:10400
  v_fmac_f32 v25, v36, v64
  v_mfma_f32_16x16x32_bf16 v[168:171], v[136:139], v[120:123], v[168:171]
  v_fmac_f32 v25, v37, v65
  v_fmac_f32 v25, v38, v66
  v_mfma_f32_16x16x32_bf16 v[172:175], v[136:139], v[124:127], v[172:175]
  buffer_load_dwordx4 v[136:139], v4, s[32:35], s43 offen offset:2048 sc1
  v_fmac_f32 v25, v39, v67
  v_fmac_f32 v25, v41, v88
  v_mfma_f32_16x16x32_bf16 v[36:39], a[84:87], a[84:87], 0
  s_waitcnt vmcnt(9)
  v_fmac_f32 v21, v44, v68
  v_fmac_f32 v21, v45, v69
  v_mfma_f32_16x16x32_bf16 v[188:191], v[140:143], v[124:127], v[188:191]
  v_fmac_f32 v21, v46, v70
  v_fmac_f32 v21, v47, v71
  v_mfma_f32_16x16x32_bf16 v[184:187], v[140:143], v[120:123], v[184:187]
  v_mfma_f32_16x16x32_bf16 v[40:43], v[52:55], a[84:87], 0
  v_fmac_f32 v21, v36, v72
  v_fmac_f32 v21, v37, v73
  v_mfma_f32_16x16x32_bf16 v[180:183], v[140:143], v[116:119], v[180:183]
  s_waitcnt lgkmcnt(0)
  v_add_u32_dpp v2, v205, v1 quad_perm:[2,2,2,2] row_mask:0xf bank_mask:0xf
  v_fmac_f32 v21, v38, v74
  v_mfma_f32_16x16x32_bf16 v[44:47], a[40:43], a[40:43], 0
  s_add_u32 m0, s44, 81120
  ds_read_b128 a[88:91], v9 offset:6240
  v_fmac_f32 v21, v39, v75
  v_mfma_f32_16x16x32_bf16 v[176:179], v[140:143], v[112:115], v[176:179]
  buffer_load_dwordx4 v2, s[28:31], 0 offen lds
  buffer_load_dwordx4 v[140:143], v4, s[32:35], s43 offen offset:3072 sc1
  v_fmac_f32 v21, v41, v89
  v_mfma_f32_16x16x32_bf16 v[36:39], v[56:59], a[40:43], 0
  s_waitcnt vmcnt(10)
  v_fmac_f32 v26, v44, v64
  v_fmac_f32 v26, v45, v65
  v_mfma_f32_16x16x32_bf16 v[160:163], v[144:147], v[96:99], v[160:163]
  s_waitcnt lgkmcnt(0)
  ds_read_b128 v[112:115], v5 offset:704
  ds_read_b128 v[116:119], v5 offset:17344
  v_mfma_f32_16x16x32_bf16 v[40:43], a[24:27], a[88:91], 0
  s_add_u32 s43, s43, 8192
  ds_read_b128 v[120:123], v5 offset:33984
  ds_read_b128 v[124:127], v5 offset:50624
  v_mfma_f32_16x16x32_bf16 v[164:167], v[144:147], v[100:103], v[164:167]
  ds_read_b128 a[44:47], v8 offset:11440
  v_fmac_f32 v26, v46, v66
  v_mfma_f32_16x16x32_bf16 v[168:171], v[144:147], v[104:107], v[168:171]
  v_fmac_f32 v26, v47, v67
  v_fmac_f32 v26, v38, v88
  v_mfma_f32_16x16x32_bf16 v[44:47], a[88:91], a[88:91], 0
  v_fmac_f32 v22, v40, v68
  v_fmac_f32 v22, v41, v69
  v_mfma_f32_16x16x32_bf16 v[172:175], v[144:147], v[108:111], v[172:175]
  s_waitcnt vmcnt(9)
  buffer_load_dwordx4 v[144:147], v4, s[32:35], s62 offen offset:0 sc1
  v_fmac_f32 v22, v42, v70
  v_fmac_f32 v22, v43, v71
  v_mfma_f32_16x16x32_bf16 v[188:191], v[148:151], v[108:111], v[188:191]
  v_xad_u32 v5, v7, 16, v11
  v_fmac_f32 v22, v44, v72
  v_mfma_f32_16x16x32_bf16 v[36:39], v[52:55], a[88:91], 0
  v_fmac_f32 v22, v45, v73
  v_fmac_f32 v22, v46, v74
  v_mfma_f32_16x16x32_bf16 v[184:187], v[148:151], v[104:107], v[184:187]
  s_waitcnt lgkmcnt(0)
  v_fmac_f32 v22, v47, v75
  v_mfma_f32_16x16x32_bf16 v[40:43], a[44:47], a[44:47], 0
  ds_read_b128 a[92:95], v9 offset:7280
  v_mfma_f32_16x16x32_bf16 v[180:183], v[148:151], v[100:103], v[180:183]
  v_fmac_f32 v22, v38, v89
  v_mfma_f32_16x16x32_bf16 v[176:179], v[148:151], v[96:99], v[176:179]
  buffer_load_dwordx4 v[148:151], v4, s[32:35], s62 offen offset:1024 sc1
  v_mfma_f32_16x16x32_bf16 v[44:47], v[56:59], a[44:47], 0
  s_waitcnt vmcnt(9)
  v_mfma_f32_16x16x32_bf16 v[160:163], v[152:155], v[112:115], v[160:163]
  s_waitcnt lgkmcnt(0)
  ds_read_b128 v[96:99], v5 offset:768
  ds_read_b128 v[100:103], v5 offset:17408
  v_mfma_f32_16x16x32_bf16 v[36:39], a[28:31], a[92:95], 0
  s_add_u32 m0, s44, 82160
  ds_read_b128 v[104:107], v5 offset:34048
  ds_read_b128 v[108:111], v5 offset:50688
  v_mfma_f32_16x16x32_bf16 v[164:167], v[152:155], v[116:119], v[164:167]
  v_xor_b32 v8, 16, v8
  ds_read_b128 a[48:51], v8 offset:12480
  v_add_u32_dpp v3, v205, v1 quad_perm:[3,3,3,3] row_mask:0xf bank_mask:0xf
  v_mfma_f32_16x16x32_bf16 v[168:171], v[152:155], v[120:123], v[168:171]
  buffer_load_dwordx4 v3, s[28:31], 0 offen lds
  v_fmac_f32 v27, v40, v64
  v_fmac_f32 v27, v41, v65
  v_fmac_f32 v27, v42, v66
  v_fmac_f32 v27, v43, v67
  v_mfma_f32_16x16x32_bf16 v[40:43], a[92:95], a[92:95], 0
  v_fmac_f32 v27, v47, v88
  v_fmac_f32 v23, v36, v68
  v_mfma_f32_16x16x32_bf16 v[172:175], v[152:155], v[124:127], v[172:175]
  buffer_load_dwordx4 v[152:155], v4, s[32:35], s62 offen offset:2048 sc1
  v_fmac_f32 v23, v37, v69
  v_fmac_f32 v23, v38, v70
  v_mfma_f32_16x16x32_bf16 v[44:47], v[52:55], a[92:95], 0
  s_waitcnt vmcnt(10)
  v_fmac_f32 v23, v39, v71
  v_fmac_f32 v23, v40, v72
  v_mfma_f32_16x16x32_bf16 v[188:191], v[156:159], v[124:127], v[188:191]
  s_waitcnt lgkmcnt(0)
  v_fmac_f32 v23, v41, v73
  v_fmac_f32 v23, v42, v74
  v_mfma_f32_16x16x32_bf16 v[36:39], a[48:51], a[48:51], 0
  ds_read_b128 a[96:99], v9 offset:8320
  v_fmac_f32 v23, v43, v75
  v_mfma_f32_16x16x32_bf16 v[184:187], v[156:159], v[120:123], v[184:187]
  v_fmac_f32 v23, v47, v89
  v_mfma_f32_16x16x32_bf16 v[180:183], v[156:159], v[116:119], v[180:183]
  v_mfma_f32_16x16x32_bf16 v[40:43], v[60:63], a[48:51], 0
  v_mfma_f32_16x16x32_bf16 v[176:179], v[156:159], v[112:115], v[176:179]
  buffer_load_dwordx4 v[156:159], v4, s[32:35], s62 offen offset:3072 sc1
  v_fmac_f32 v28, v36, v64
  v_fmac_f32 v28, v37, v65
  v_mfma_f32_16x16x32_bf16 v[44:47], v[60:63], v[60:63], 0
  s_waitcnt vmcnt(10)
  v_fmac_f32 v28, v38, v66
  v_fmac_f32 v28, v39, v67
  v_mfma_f32_16x16x32_bf16 v[160:163], v[128:131], v[96:99], v[160:163]
  s_waitcnt lgkmcnt(0)
  ds_read_b128 v[112:115], v5 offset:832
  ds_read_b128 v[116:119], v5 offset:17472
  v_mfma_f32_16x16x32_bf16 v[36:39], a[32:35], a[96:99], 0
  s_add_u32 s62, s62, 8192
  ds_read_b128 v[120:123], v5 offset:34112
  ds_read_b128 v[124:127], v5 offset:50752
  v_mfma_f32_16x16x32_bf16 v[164:167], v[128:131], v[100:103], v[164:167]
  ds_read_b128 a[52:55], v8 offset:13520
  v_fmac_f32 v28, v40, v88
  v_mfma_f32_16x16x32_bf16 v[40:43], a[96:99], a[96:99], 0
  v_fmac_f32 v28, v44, v12
  v_fmac_f32 v29, v45, v13
  v_mfma_f32_16x16x32_bf16 v[168:171], v[128:131], v[104:107], v[168:171]
  v_fmac_f32 v30, v46, v14
  v_fmac_f32 v31, v47, v15
  v_mfma_f32_16x16x32_bf16 v[44:47], v[56:59], a[96:99], 0
  v_fmac_f32 v24, v36, v68
  v_fmac_f32 v24, v37, v69
  v_mfma_f32_16x16x32_bf16 v[172:175], v[128:131], v[108:111], v[172:175]
  s_waitcnt vmcnt(8)
  buffer_load_dwordx4 v[128:131], v4, s[32:35], s43 offen offset:0 sc1
  v_fmac_f32 v24, v38, v70
  v_fmac_f32 v24, v39, v71
  v_mfma_f32_16x16x32_bf16 v[188:191], v[132:135], v[108:111], v[188:191]
  s_waitcnt lgkmcnt(0)
  v_fmac_f32 v24, v40, v72
  v_fmac_f32 v24, v41, v73
  v_mfma_f32_16x16x32_bf16 v[36:39], a[52:55], a[52:55], 0
  ds_read_b128 a[100:103], v9 offset:9360
  v_fmac_f32 v24, v42, v74
  v_mfma_f32_16x16x32_bf16 v[184:187], v[132:135], v[104:107], v[184:187]
  v_fmac_f32 v24, v43, v75
  v_fmac_f32 v24, v44, v89
  v_mfma_f32_16x16x32_bf16 v[180:183], v[132:135], v[100:103], v[180:183]
  v_mfma_f32_16x16x32_bf16 v[40:43], v[60:63], a[52:55], 0
  v_mfma_f32_16x16x32_bf16 v[176:179], v[132:135], v[96:99], v[176:179]
  s_waitcnt vmcnt(8)
  buffer_load_dwordx4 v[132:135], v4, s[32:35], s43 offen offset:1024 sc1
  v_fmac_f32 v29, v36, v64
  v_fmac_f32 v29, v37, v65
  v_mfma_f32_16x16x32_bf16 v[160:163], v[136:139], v[112:115], v[160:163]
  s_waitcnt lgkmcnt(0)
  ds_read_b128 v[96:99], v5 offset:896
  ds_read_b128 v[100:103], v5 offset:17536
  v_mfma_f32_16x16x32_bf16 v[44:47], a[36:39], a[100:103], 0
  ds_read_b128 v[104:107], v5 offset:34176
  ds_read_b128 v[108:111], v5 offset:50816
  v_mfma_f32_16x16x32_bf16 v[164:167], v[136:139], v[116:119], v[164:167]
  ds_read_b128 a[56:59], v8 offset:14560
  v_fmac_f32 v29, v38, v66
  v_fmac_f32 v29, v39, v67
  v_mfma_f32_16x16x32_bf16 v[36:39], a[100:103], a[100:103], 0
  v_fmac_f32 v29, v41, v88
  v_fmac_f32 v25, v44, v68
  v_mfma_f32_16x16x32_bf16 v[40:43], v[56:59], a[100:103], 0
  v_fmac_f32 v25, v45, v69
  v_fmac_f32 v25, v46, v70
  v_mfma_f32_16x16x32_bf16 v[168:171], v[136:139], v[120:123], v[168:171]
  v_fmac_f32 v25, v47, v71
  v_mfma_f32_16x16x32_bf16 v[172:175], v[136:139], v[124:127], v[172:175]
  s_waitcnt lgkmcnt(0)
  buffer_load_dwordx4 v[136:139], v4, s[32:35], s43 offen offset:2048 sc1
  v_fmac_f32 v25, v36, v72
  v_fmac_f32 v25, v37, v73
  v_mfma_f32_16x16x32_bf16 v[44:47], a[56:59], a[56:59], 0
  s_waitcnt vmcnt(8)
  ds_read_b128 a[104:107], v9 offset:10400
  v_fmac_f32 v25, v38, v74
  v_mfma_f32_16x16x32_bf16 v[188:191], v[140:143], v[124:127], v[188:191]
  v_fmac_f32 v25, v39, v75
  v_fmac_f32 v25, v41, v89
  v_mfma_f32_16x16x32_bf16 v[184:187], v[140:143], v[120:123], v[184:187]
  v_mfma_f32_16x16x32_bf16 v[180:183], v[140:143], v[116:119], v[180:183]
  v_fmac_f32 v30, v44, v64
  v_fmac_f32 v30, v45, v65
  v_mfma_f32_16x16x32_bf16 v[36:39], v[60:63], a[56:59], 0
  v_fmac_f32 v30, v46, v66
  v_fmac_f32 v30, v47, v67
  v_mfma_f32_16x16x32_bf16 v[176:179], v[140:143], v[112:115], v[176:179]
  s_waitcnt vmcnt(7)
  buffer_load_dwordx4 v[140:143], v4, s[32:35], s43 offen offset:3072 sc1
  v_mfma_f32_16x16x32_bf16 v[160:163], v[144:147], v[96:99], v[160:163]
  s_waitcnt lgkmcnt(0)
  ds_read_b128 v[112:115], v5 offset:960
  ds_read_b128 v[116:119], v5 offset:17600
  v_mfma_f32_16x16x32_bf16 v[40:43], a[40:43], a[104:107], 0
  s_add_u32 s43, s43, 8192
  ds_read_b128 v[120:123], v5 offset:34240
  ds_read_b128 v[124:127], v5 offset:50880
  v_mfma_f32_16x16x32_bf16 v[44:47], a[104:107], a[104:107], 0
  ds_read_b128 a[60:63], v8 offset:15600
  v_fmac_f32 v30, v38, v88
  v_mfma_f32_16x16x32_bf16 v[36:39], v[56:59], a[104:107], 0
  v_mfma_f32_16x16x32_bf16 v[164:167], v[144:147], v[100:103], v[164:167]
  v_fmac_f32 v26, v40, v68
  v_fmac_f32 v26, v41, v69
  v_mfma_f32_16x16x32_bf16 v[168:171], v[144:147], v[104:107], v[168:171]
  s_waitcnt lgkmcnt(0)
  v_fmac_f32 v26, v42, v70
  v_fmac_f32 v26, v43, v71
  v_mfma_f32_16x16x32_bf16 v[40:43], a[60:63], a[60:63], 0
  ds_read_b128 a[108:111], v9 offset:11440
  v_fmac_f32 v26, v44, v72
  v_mfma_f32_16x16x32_bf16 v[172:175], v[144:147], v[108:111], v[172:175]
  s_waitcnt vmcnt(7)
  buffer_load_dwordx4 v[144:147], v4, s[32:35], s62 offen offset:0 sc1
  v_fmac_f32 v26, v45, v73
  v_fmac_f32 v26, v46, v74
  v_mfma_f32_16x16x32_bf16 v[188:191], v[148:151], v[108:111], v[188:191]
  v_add_u32 v11, 66560, v11
  v_xad_u32 v5, v7, 0, v11
  v_mfma_f32_16x16x32_bf16 v[184:187], v[148:151], v[104:107], v[184:187]
  v_fmac_f32 v26, v47, v75
  v_fmac_f32 v26, v38, v89
  v_mfma_f32_16x16x32_bf16 v[180:183], v[148:151], v[100:103], v[180:183]
  v_fmac_f32 v31, v40, v64
  v_fmac_f32 v31, v41, v65
  v_mfma_f32_16x16x32_bf16 v[44:47], v[60:63], a[60:63], 0
  v_fmac_f32 v31, v42, v66
  v_fmac_f32 v31, v43, v67
  v_mfma_f32_16x16x32_bf16 v[176:179], v[148:151], v[96:99], v[176:179]
  s_waitcnt vmcnt(6)
  s_barrier
  buffer_load_dwordx4 v[148:151], v4, s[32:35], s62 offen offset:1024 sc1
  ds_read_b128 v[64:67], v10 offset:9216
  v_mfma_f32_16x16x32_bf16 v[160:163], v[152:155], v[112:115], v[160:163]
  ds_read_b128 v[96:99], v5 offset:0
  ds_read_b128 v[100:103], v5 offset:16640
  v_mfma_f32_16x16x32_bf16 v[164:167], v[152:155], v[116:119], v[164:167]
  s_waitcnt lgkmcnt(3)
  ds_read_b128 v[104:107], v5 offset:33280
  ds_read_b128 v[108:111], v5 offset:49920
  v_mfma_f32_16x16x32_bf16 v[36:39], a[44:47], a[108:111], 0
  s_add_u32 m0, s44, 0
  v_xor_b32 v9, 16, v9
  ds_read_b128 a[112:115], v9 offset:12480
  v_add_u32_dpp v2, v194, v1 quad_perm:[0,0,0,0] row_mask:0xf bank_mask:0xf
  v_mfma_f32_16x16x32_bf16 v[168:171], v[152:155], v[120:123], v[168:171]
  buffer_load_dwordx4 v2, s[28:31], 0 offen lds
  v_fmac_f32 v31, v47, v88
  v_mfma_f32_16x16x32_bf16 v[172:175], v[152:155], v[124:127], v[172:175]
  s_waitcnt vmcnt(7)
  buffer_load_dwordx4 v[152:155], v4, s[32:35], s62 offen offset:2048 sc1
  ds_read_b32 v88, v10 offset:2048
  v_fmac_f32 v27, v36, v68
  v_mfma_f32_16x16x32_bf16 v[188:191], v[156:159], v[124:127], v[188:191]
  v_fmac_f32 v27, v37, v69
  v_fmac_f32 v27, v38, v70
  v_mfma_f32_16x16x32_bf16 v[40:43], a[108:111], a[108:111], 0
  v_fmac_f32 v27, v39, v71
  v_mfma_f32_16x16x32_bf16 v[184:187], v[156:159], v[120:123], v[184:187]
  v_mfma_f32_16x16x32_bf16 v[180:183], v[156:159], v[116:119], v[180:183]
  v_mfma_f32_16x16x32_bf16 v[44:47], v[56:59], a[108:111], 0
  s_add_u32 m0, s44, 1040
  v_add_u32_dpp v3, v194, v1 quad_perm:[1,1,1,1] row_mask:0xf bank_mask:0xf
  v_mfma_f32_16x16x32_bf16 v[176:179], v[156:159], v[112:115], v[176:179]
  s_waitcnt vmcnt(7) lgkmcnt(4)
  buffer_load_dwordx4 v3, s[28:31], 0 offen lds
  buffer_load_dwordx4 v[156:159], v4, s[32:35], s62 offen offset:3072 sc1
  v_fmac_f32 v27, v40, v72
  v_mfma_f32_16x16x32_bf16 v[160:163], v[128:131], v[96:99], v[160:163]
  s_add_u32 s62, s62, 8192
  ds_read_b128 v[112:115], v5 offset:64
  ds_read_b128 v[116:119], v5 offset:16704
  v_mfma_f32_16x16x32_bf16 v[164:167], v[128:131], v[100:103], v[164:167]
  s_waitcnt lgkmcnt(3)
  ds_read_b128 v[120:123], v5 offset:33344
  ds_read_b128 v[124:127], v5 offset:49984
  v_mfma_f32_16x16x32_bf16 v[36:39], a[48:51], a[112:115], 0
  ds_read_b128 a[116:119], v9 offset:13520
  v_fmac_f32 v27, v41, v73
  v_mfma_f32_16x16x32_bf16 v[168:171], v[128:131], v[104:107], v[168:171]
  v_fmac_f32 v27, v42, v74
  v_fmac_f32 v27, v43, v75
  v_mfma_f32_16x16x32_bf16 v[172:175], v[128:131], v[108:111], v[172:175]
  s_waitcnt vmcnt(8)
  buffer_load_dwordx4 v[128:131], v4, s[32:35], s43 offen offset:0 sc1
  v_fmac_f32 v27, v47, v89
  v_fmac_f32 v28, v36, v68
  v_mfma_f32_16x16x32_bf16 v[188:191], v[132:135], v[108:111], v[188:191]
  v_fmac_f32 v28, v37, v69
  v_fmac_f32 v28, v38, v70
  v_mfma_f32_16x16x32_bf16 v[40:43], a[112:115], a[112:115], 0
  v_fmac_f32 v28, v39, v71
  v_mfma_f32_16x16x32_bf16 v[184:187], v[132:135], v[104:107], v[184:187]
  s_add_u32 m0, s44, 2080
  v_add_u32_dpp v2, v194, v1 quad_perm:[2,2,2,2] row_mask:0xf bank_mask:0xf
  v_mfma_f32_16x16x32_bf16 v[180:183], v[132:135], v[100:103], v[180:183]
  buffer_load_dwordx4 v2, s[28:31], 0 offen lds
  v_mfma_f32_16x16x32_bf16 v[44:47], v[60:63], a[112:115], 0
  v_mfma_f32_16x16x32_bf16 v[176:179], v[132:135], v[96:99], v[176:179]
  s_waitcnt vmcnt(9) lgkmcnt(3)
  buffer_load_dwordx4 v[132:135], v4, s[32:35], s43 offen offset:1024 sc1
  v_fmac_f32 v28, v40, v72
  v_fmac_f32 v28, v41, v73
  v_mfma_f32_16x16x32_bf16 v[160:163], v[136:139], v[112:115], v[160:163]
  ds_read_b128 v[96:99], v5 offset:128
  ds_read_b128 v[100:103], v5 offset:16768
  v_mfma_f32_16x16x32_bf16 v[164:167], v[136:139], v[116:119], v[164:167]
  s_waitcnt lgkmcnt(2)
  ds_read_b128 v[104:107], v5 offset:33408
  ds_read_b128 v[108:111], v5 offset:50048
  v_mfma_f32_16x16x32_bf16 v[36:39], a[52:55], a[116:119], 0
  s_add_u32 m0, s41, 145408
  ds_read_b128 a[120:123], v9 offset:14560
  v_fmac_f32 v28, v42, v74
  v_mfma_f32_16x16x32_bf16 v[168:171], v[136:139], v[120:123], v[168:171]
  buffer_load_dwordx4 v4, s[32:35], s73 offen sc1 lds
  s_add_u32 s73, s73, 4096
  v_fmac_f32 v28, v43, v75
  v_mfma_f32_16x16x32_bf16 v[172:175], v[136:139], v[124:127], v[172:175]
  s_waitcnt vmcnt(10)
  buffer_load_dwordx4 v[136:139], v4, s[32:35], s43 offen offset:2048 sc1
  v_fmac_f32 v28, v44, v89
  v_fmac_f32 v29, v36, v68
  v_mfma_f32_16x16x32_bf16 v[188:191], v[140:143], v[124:127], v[188:191]
  s_add_u32 m0, s44, 3120
  v_add_u32_dpp v3, v194, v1 quad_perm:[3,3,3,3] row_mask:0xf bank_mask:0xf
  v_fmac_f32 v29, v37, v69
  v_mfma_f32_16x16x32_bf16 v[40:43], a[116:119], a[116:119], 0
  buffer_load_dwordx4 v3, s[28:31], 0 offen lds
  v_fmac_f32 v29, v38, v70
  v_mfma_f32_16x16x32_bf16 v[184:187], v[140:143], v[120:123], v[184:187]
  v_fmac_f32 v29, v39, v71
  v_mfma_f32_16x16x32_bf16 v[180:183], v[140:143], v[116:119], v[180:183]
  v_mfma_f32_16x16x32_bf16 v[44:47], v[60:63], a[116:119], 0
  v_mfma_f32_16x16x32_bf16 v[176:179], v[140:143], v[112:115], v[176:179]
  s_waitcnt vmcnt(11) lgkmcnt(3)
  buffer_load_dwordx4 v[140:143], v4, s[32:35], s43 offen offset:3072 sc1
  v_fmac_f32 v29, v40, v72
  v_fmac_f32 v29, v41, v73
  v_mfma_f32_16x16x32_bf16 v[160:163], v[144:147], v[96:99], v[160:163]
  s_add_u32 s43, s43, 8192
  ds_read_b128 v[112:115], v5 offset:192
  ds_read_b128 v[116:119], v5 offset:16832
  v_mfma_f32_16x16x32_bf16 v[164:167], v[144:147], v[100:103], v[164:167]
  s_waitcnt lgkmcnt(2)
  ds_read_b128 v[120:123], v5 offset:33472
  ds_read_b128 v[124:127], v5 offset:50112
  v_mfma_f32_16x16x32_bf16 v[36:39], a[56:59], a[120:123], 0
  ds_read_b128 a[124:127], v9 offset:15600
  v_fmac_f32 v29, v42, v74
  v_mfma_f32_16x16x32_bf16 v[168:171], v[144:147], v[104:107], v[168:171]
  s_add_u32 m0, s44, 4160
  v_add_u32_dpp v2, v198, v6 quad_perm:[0,0,0,0] row_mask:0xf bank_mask:0xf
  v_fmac_f32 v29, v43, v75
  v_mfma_f32_16x16x32_bf16 v[172:175], v[144:147], v[108:111], v[172:175]
  s_waitcnt vmcnt(11)
  buffer_load_dwordx4 v2, s[28:31], 0 offen lds
  buffer_load_dwordx4 v[144:147], v4, s[32:35], s62 offen offset:0 sc1
  v_fmac_f32 v29, v45, v89
  v_mfma_f32_16x16x32_bf16 v[188:191], v[148:151], v[108:111], v[188:191]
  v_xad_u32 v5, v7, 48, v11
  v_fmac_f32 v30, v36, v68
  v_mfma_f32_16x16x32_bf16 v[40:43], a[120:123], a[120:123], 0
  v_fmac_f32 v30, v37, v69
  v_fmac_f32 v30, v38, v70
  v_mfma_f32_16x16x32_bf16 v[184:187], v[148:151], v[104:107], v[184:187]
  v_fmac_f32 v30, v39, v71
  v_mfma_f32_16x16x32_bf16 v[180:183], v[148:151], v[100:103], v[180:183]
  v_mfma_f32_16x16x32_bf16 v[44:47], v[60:63], a[120:123], 0
  v_mfma_f32_16x16x32_bf16 v[176:179], v[148:151], v[96:99], v[176:179]
  s_waitcnt vmcnt(11) lgkmcnt(3)
  buffer_load_dwordx4 v[148:151], v4, s[32:35], s62 offen offset:1024 sc1
  v_fmac_f32 v30, v40, v72
  v_fmac_f32 v30, v41, v73
  v_mfma_f32_16x16x32_bf16 v[160:163], v[152:155], v[112:115], v[160:163]
  ds_read_b128 v[96:99], v5 offset:256
  ds_read_b128 v[100:103], v5 offset:16896
  v_mfma_f32_16x16x32_bf16 v[164:167], v[152:155], v[116:119], v[164:167]
  s_waitcnt lgkmcnt(2)
  ds_read_b128 v[104:107], v5 offset:33536
  ds_read_b128 v[108:111], v5 offset:50176
  v_mfma_f32_16x16x32_bf16 v[36:39], a[60:63], a[124:127], 0
  s_add_u32 m0, s44, 5200
  ds_read_b128 a[128:131], v8 offset:0
  v_add_u32_dpp v3, v198, v6 quad_perm:[1,1,1,1] row_mask:0xf bank_mask:0xf
  v_mfma_f32_16x16x32_bf16 v[168:171], v[152:155], v[120:123], v[168:171]
  buffer_load_dwordx4 v3, s[28:31], 0 offen lds
  v_fmac_f32 v30, v42, v74
  v_mfma_f32_16x16x32_bf16 v[172:175], v[152:155], v[124:127], v[172:175]
  s_waitcnt vmcnt(11)
  buffer_load_dwordx4 v[152:155], v4, s[32:35], s62 offen offset:2048 sc1
  v_fmac_f32 v30, v43, v75
  v_fmac_f32 v30, v46, v89
  v_mfma_f32_16x16x32_bf16 v[188:191], v[156:159], v[124:127], v[188:191]
  v_fmac_f32 v31, v36, v68
  v_fmac_f32 v31, v37, v69
  v_mfma_f32_16x16x32_bf16 v[40:43], a[124:127], a[124:127], 0
  v_fmac_f32 v31, v38, v70
  v_fmac_f32 v31, v39, v71
  v_mfma_f32_16x16x32_bf16 v[184:187], v[156:159], v[120:123], v[184:187]
  ds_read_b128 v[68:71], v10 offset:10240
  v_mfma_f32_16x16x32_bf16 v[180:183], v[156:159], v[116:119], v[180:183]
  v_mfma_f32_16x16x32_bf16 v[44:47], v[60:63], a[124:127], 0
  s_add_u32 m0, s44, 6240
  v_add_u32_dpp v2, v198, v6 quad_perm:[2,2,2,2] row_mask:0xf bank_mask:0xf
  v_fmac_f32 v31, v40, v72
  v_mfma_f32_16x16x32_bf16 v[176:179], v[156:159], v[112:115], v[176:179]
  s_waitcnt vmcnt(11) lgkmcnt(4)
  buffer_load_dwordx4 v2, s[28:31], 0 offen lds
  buffer_load_dwordx4 v[156:159], v4, s[32:35], s62 offen offset:3072 sc1
  v_fmac_f32 v31, v41, v73
  v_mfma_f32_16x16x32_bf16 v[160:163], v[128:131], v[96:99], v[160:163]
  s_add_u32 s62, s62, 8192
  ds_read_b128 v[112:115], v5 offset:320
  ds_read_b128 v[116:119], v5 offset:16960
  v_mfma_f32_16x16x32_bf16 v[164:167], v[128:131], v[100:103], v[164:167]
  s_waitcnt lgkmcnt(3)
  ds_read_b128 v[120:123], v5 offset:33600
  ds_read_b128 v[124:127], v5 offset:50240
  v_mfma_f32_16x16x32_bf16 v[36:39], a[0:3], a[128:131], 0
  s_add_u32 m0, s41, 149504
  ds_read_b128 a[132:135], v8 offset:1040
  v_fmac_f32 v31, v42, v74
  v_mfma_f32_16x16x32_bf16 v[168:171], v[128:131], v[104:107], v[168:171]
  buffer_load_dwordx4 v4, s[32:35], s73 offen sc1 lds
  s_add_u32 s73, s73, 4096
  v_fmac_f32 v31, v43, v75
  v_mfma_f32_16x16x32_bf16 v[172:175], v[128:131], v[108:111], v[172:175]
  buffer_load_dwordx4 v[128:131], v4, s[32:35], s43 offen offset:0 sc1
  ds_read_b128 v[72:75], v10 offset:11264
  v_fmac_f32 v31, v47, v89
  v_mfma_f32_16x16x32_bf16 v[40:43], a[64:67], a[128:131], 0
  s_waitcnt vmcnt(13)
  ds_read_b32 v89, v10 offset:2052
  v_fmac_f32 v16, v36, v76
  v_mfma_f32_16x16x32_bf16 v[188:191], v[132:135], v[108:111], v[188:191]
  v_fmac_f32 v16, v37, v77
  v_fmac_f32 v16, v38, v78
  v_mfma_f32_16x16x32_bf16 v[184:187], v[132:135], v[104:107], v[184:187]
  s_add_u32 m0, s44, 7280
  v_add_u32_dpp v3, v198, v6 quad_perm:[3,3,3,3] row_mask:0xf bank_mask:0xf
  v_fmac_f32 v16, v39, v79
  v_mfma_f32_16x16x32_bf16 v[44:47], a[128:131], a[128:131], 0
  buffer_load_dwordx4 v3, s[28:31], 0 offen lds
  v_fmac_f32 v16, v40, v80
  v_mfma_f32_16x16x32_bf16 v[180:183], v[132:135], v[100:103], v[180:183]
  v_fmac_f32 v16, v41, v81
  v_fmac_f32 v16, v42, v82
  v_mfma_f32_16x16x32_bf16 v[176:179], v[132:135], v[96:99], v[176:179]
  buffer_load_dwordx4 v[132:135], v4, s[32:35], s43 offen offset:1024 sc1
  v_fmac_f32 v16, v43, v83
  v_fmac_f32 v16, v44, v84
  v_mfma_f32_16x16x32_bf16 v[36:39], v[48:51], a[128:131], 0
  s_waitcnt vmcnt(13) lgkmcnt(5)
  v_fmac_f32 v16, v45, v85
  v_fmac_f32 v16, v46, v86
  v_mfma_f32_16x16x32_bf16 v[160:163], v[136:139], v[112:115], v[160:163]
  ds_read_b128 v[96:99], v5 offset:384
  ds_read_b128 v[100:103], v5 offset:17024
  v_mfma_f32_16x16x32_bf16 v[164:167], v[136:139], v[116:119], v[164:167]
  s_waitcnt lgkmcnt(4)
  ds_read_b128 v[104:107], v5 offset:33664
  ds_read_b128 v[108:111], v5 offset:50304
  v_mfma_f32_16x16x32_bf16 v[40:43], a[4:7], a[132:135], 0
  ds_read_b128 a[136:139], v8 offset:2080
  v_fmac_f32 v16, v47, v87
  v_mfma_f32_16x16x32_bf16 v[168:171], v[136:139], v[120:123], v[168:171]
  v_fmac_f32 v16, v36, v90
  v_mfma_f32_16x16x32_bf16 v[172:175], v[136:139], v[124:127], v[172:175]
  buffer_load_dwordx4 v[136:139], v4, s[32:35], s43 offen offset:2048 sc1
  v_mfma_f32_16x16x32_bf16 v[44:47], a[68:71], a[132:135], 0
  s_waitcnt vmcnt(12)
  v_fmac_f32 v17, v40, v76
  v_fmac_f32 v17, v41, v77
  v_mfma_f32_16x16x32_bf16 v[188:191], v[140:143], v[124:127], v[188:191]
  s_add_u32 m0, s44, 8320
  v_add_u32_dpp v2, v202, v6 quad_perm:[0,0,0,0] row_mask:0xf bank_mask:0xf
  v_fmac_f32 v17, v42, v78
  v_mfma_f32_16x16x32_bf16 v[184:187], v[140:143], v[120:123], v[184:187]
  buffer_load_dwordx4 v2, s[28:31], 0 offen lds
  v_fmac_f32 v17, v43, v79
  v_mfma_f32_16x16x32_bf16 v[36:39], a[132:135], a[132:135], 0
  v_fmac_f32 v17, v44, v80
  v_fmac_f32 v17, v45, v81
  v_mfma_f32_16x16x32_bf16 v[180:183], v[140:143], v[116:119], v[180:183]
  v_fmac_f32 v17, v46, v82
  v_fmac_f32 v17, v47, v83
  v_mfma_f32_16x16x32_bf16 v[176:179], v[140:143], v[112:115], v[176:179]
  buffer_load_dwordx4 v[140:143], v4, s[32:35], s43 offen offset:3072 sc1
  v_mfma_f32_16x16x32_bf16 v[40:43], v[48:51], a[132:135], 0
  s_waitcnt vmcnt(12) lgkmcnt(3)
  v_fmac_f32 v17, v36, v84
  v_fmac_f32 v17, v37, v85
  v_mfma_f32_16x16x32_bf16 v[160:163], v[144:147], v[96:99], v[160:163]
  s_add_u32 s43, s43, 8192
  ds_read_b128 v[112:115], v5 offset:448
  ds_read_b128 v[116:119], v5 offset:17088
  v_mfma_f32_16x16x32_bf16 v[164:167], v[144:147], v[100:103], v[164:167]
  s_waitcnt lgkmcnt(2)
  ds_read_b128 v[120:123], v5 offset:33728
  ds_read_b128 v[124:127], v5 offset:50368
  v_mfma_f32_16x16x32_bf16 v[44:47], a[8:11], a[136:139], 0
  ds_read_b128 a[140:143], v8 offset:3120
  v_fmac_f32 v17, v38, v86
  v_mfma_f32_16x16x32_bf16 v[168:171], v[144:147], v[104:107], v[168:171]
  s_add_u32 m0, s44, 9360
  v_add_u32_dpp v3, v202, v6 quad_perm:[1,1,1,1] row_mask:0xf bank_mask:0xf
  v_fmac_f32 v17, v39, v87
  v_mfma_f32_16x16x32_bf16 v[172:175], v[144:147], v[108:111], v[172:175]
  buffer_load_dwordx4 v3, s[28:31], 0 offen lds
  buffer_load_dwordx4 v[144:147], v4, s[32:35], s62 offen offset:0 sc1
  v_fmac_f32 v17, v41, v90
  v_mfma_f32_16x16x32_bf16 v[36:39], a[72:75], a[136:139], 0
  s_waitcnt vmcnt(13)
  v_fmac_f32 v18, v44, v76
  v_fmac_f32 v18, v45, v77
  v_mfma_f32_16x16x32_bf16 v[188:191], v[148:151], v[108:111], v[188:191]
  v_xad_u32 v5, v7, 32, v11
  v_fmac_f32 v18, v46, v78
  v_mfma_f32_16x16x32_bf16 v[184:187], v[148:151], v[104:107], v[184:187]
  v_fmac_f32 v18, v47, v79
  v_fmac_f32 v18, v36, v80
  v_mfma_f32_16x16x32_bf16 v[40:43], a[136:139], a[136:139], 0
  v_fmac_f32 v18, v37, v81
  v_fmac_f32 v18, v38, v82
  v_mfma_f32_16x16x32_bf16 v[180:183], v[148:151], v[100:103], v[180:183]
  v_fmac_f32 v18, v39, v83
  v_mfma_f32_16x16x32_bf16 v[176:179], v[148:151], v[96:99], v[176:179]
  buffer_load_dwordx4 v[148:151], v4, s[32:35], s62 offen offset:1024 sc1
  v_mfma_f32_16x16x32_bf16 v[44:47], v[48:51], a[136:139], 0
  s_waitcnt vmcnt(12) lgkmcnt(3)
  v_fmac_f32 v18, v40, v84
  v_fmac_f32 v18, v41, v85
  v_mfma_f32_16x16x32_bf16 v[160:163], v[152:155], v[112:115], v[160:163]
  ds_read_b128 v[96:99], v5 offset:512
  ds_read_b128 v[100:103], v5 offset:17152
  v_mfma_f32_16x16x32_bf16 v[164:167], v[152:155], v[116:119], v[164:167]
  s_waitcnt lgkmcnt(2)
  ds_read_b128 v[104:107], v5 offset:33792
  ds_read_b128 v[108:111], v5 offset:50432
  v_mfma_f32_16x16x32_bf16 v[36:39], a[12:15], a[140:143], 0
  s_add_u32 m0, s44, 10400
  v_xor_b32 v8, 16, v8
  ds_read_b128 a[144:147], v8 offset:4160
  v_add_u32_dpp v2, v202, v6 quad_perm:[2,2,2,2] row_mask:0xf bank_mask:0xf
  v_mfma_f32_16x16x32_bf16 v[168:171], v[152:155], v[120:123], v[168:171]
  buffer_load_dwordx4 v2, s[28:31], 0 offen lds
  v_fmac_f32 v18, v42, v86
  v_mfma_f32_16x16x32_bf16 v[172:175], v[152:155], v[124:127], v[172:175]
  s_add_u32 m0, s41, 153600
  buffer_load_dwordx4 v[152:155], v4, s[32:35], s62 offen offset:2048 sc1
  v_fmac_f32 v18, v43, v87
  v_fmac_f32 v18, v46, v90
  v_mfma_f32_16x16x32_bf16 v[40:43], a[76:79], a[140:143], 0
  s_waitcnt vmcnt(12)
  buffer_load_dwordx4 v4, s[32:35], s73 offen sc1 lds
  s_add_u32 s73, s73, 4096
  v_fmac_f32 v19, v36, v76
  v_mfma_f32_16x16x32_bf16 v[188:191], v[156:159], v[124:127], v[188:191]
  v_fmac_f32 v19, v37, v77
  v_fmac_f32 v19, v38, v78
  v_mfma_f32_16x16x32_bf16 v[184:187], v[156:159], v[120:123], v[184:187]
  v_fmac_f32 v19, v39, v79
  v_fmac_f32 v19, v40, v80
  v_mfma_f32_16x16x32_bf16 v[44:47], a[140:143], a[140:143], 0
  v_fmac_f32 v19, v41, v81
  v_fmac_f32 v19, v42, v82
  v_mfma_f32_16x16x32_bf16 v[180:183], v[156:159], v[116:119], v[180:183]
  v_fmac_f32 v19, v43, v83
  v_mfma_f32_16x16x32_bf16 v[176:179], v[156:159], v[112:115], v[176:179]
  s_add_u32 m0, s44, 11440
  buffer_load_dwordx4 v[156:159], v4, s[32:35], s62 offen offset:3072 sc1
  v_add_u32_dpp v3, v202, v6 quad_perm:[3,3,3,3] row_mask:0xf bank_mask:0xf
  v_fmac_f32 v19, v44, v84
  v_mfma_f32_16x16x32_bf16 v[36:39], v[48:51], a[140:143], 0
  s_waitcnt vmcnt(12) lgkmcnt(3)
  buffer_load_dwordx4 v3, s[28:31], 0 offen lds
  v_fmac_f32 v19, v45, v85
  v_mfma_f32_16x16x32_bf16 v[160:163], v[128:131], v[96:99], v[160:163]
  s_add_u32 s62, s62, 8192
  ds_read_b128 v[112:115], v5 offset:576
  ds_read_b128 v[116:119], v5 offset:17216
  v_mfma_f32_16x16x32_bf16 v[164:167], v[128:131], v[100:103], v[164:167]
  s_waitcnt lgkmcnt(2)
  ds_read_b128 v[120:123], v5 offset:33856
  ds_read_b128 v[124:127], v5 offset:50496
  v_mfma_f32_16x16x32_bf16 v[40:43], a[16:19], a[144:147], 0
  ds_read_b128 a[148:151], v8 offset:5200
  v_fmac_f32 v19, v46, v86
  v_mfma_f32_16x16x32_bf16 v[168:171], v[128:131], v[104:107], v[168:171]
  v_fmac_f32 v19, v47, v87
  v_fmac_f32 v19, v39, v90
  v_mfma_f32_16x16x32_bf16 v[172:175], v[128:131], v[108:111], v[172:175]
  buffer_load_dwordx4 v[128:131], v4, s[32:35], s43 offen offset:0 sc1
  v_mfma_f32_16x16x32_bf16 v[44:47], a[80:83], a[144:147], 0
  s_waitcnt vmcnt(12)
  v_fmac_f32 v20, v40, v76
  v_fmac_f32 v20, v41, v77
  v_mfma_f32_16x16x32_bf16 v[188:191], v[132:135], v[108:111], v[188:191]
  v_fmac_f32 v20, v42, v78
  v_fmac_f32 v20, v43, v79
  v_mfma_f32_16x16x32_bf16 v[184:187], v[132:135], v[104:107], v[184:187]
  s_add_u32 m0, s44, 12480
  v_add_u32_dpp v2, v206, v1 quad_perm:[0,0,0,0] row_mask:0xf bank_mask:0xf
  v_fmac_f32 v20, v44, v80
  v_mfma_f32_16x16x32_bf16 v[36:39], a[144:147], a[144:147], 0
  buffer_load_dwordx4 v2, s[28:31], 0 offen lds
  v_fmac_f32 v20, v45, v81
  v_mfma_f32_16x16x32_bf16 v[180:183], v[132:135], v[100:103], v[180:183]
  v_fmac_f32 v20, v46, v82
  v_fmac_f32 v20, v47, v83
  v_mfma_f32_16x16x32_bf16 v[176:179], v[132:135], v[96:99], v[176:179]
  buffer_load_dwordx4 v[132:135], v4, s[32:35], s43 offen offset:1024 sc1
  v_mfma_f32_16x16x32_bf16 v[40:43], v[52:55], a[144:147], 0
  s_waitcnt vmcnt(13) lgkmcnt(3)
  v_fmac_f32 v20, v36, v84
  v_fmac_f32 v20, v37, v85
  v_mfma_f32_16x16x32_bf16 v[160:163], v[136:139], v[112:115], v[160:163]
  ds_read_b128 v[96:99], v5 offset:640
  ds_read_b128 v[100:103], v5 offset:17280
  v_mfma_f32_16x16x32_bf16 v[164:167], v[136:139], v[116:119], v[164:167]
  s_waitcnt lgkmcnt(2)
  ds_read_b128 v[104:107], v5 offset:33920
  ds_read_b128 v[108:111], v5 offset:50560
  v_mfma_f32_16x16x32_bf16 v[44:47], a[20:23], a[148:151], 0
  ds_read_b128 a[152:155], v8 offset:6240
  v_fmac_f32 v20, v38, v86
  v_mfma_f32_16x16x32_bf16 v[168:171], v[136:139], v[120:123], v[168:171]
  v_fmac_f32 v20, v39, v87
  v_fmac_f32 v20, v40, v90
  v_mfma_f32_16x16x32_bf16 v[172:175], v[136:139], v[124:127], v[172:175]
  buffer_load_dwordx4 v[136:139], v4, s[32:35], s43 offen offset:2048 sc1
  v_mfma_f32_16x16x32_bf16 v[36:39], a[84:87], a[148:151], 0
  s_waitcnt vmcnt(12)
  v_fmac_f32 v21, v44, v76
  v_fmac_f32 v21, v45, v77
  v_mfma_f32_16x16x32_bf16 v[188:191], v[140:143], v[124:127], v[188:191]
  s_add_u32 m0, s44, 13520
  v_add_u32_dpp v3, v206, v1 quad_perm:[1,1,1,1] row_mask:0xf bank_mask:0xf
  v_fmac_f32 v21, v46, v78
  v_mfma_f32_16x16x32_bf16 v[184:187], v[140:143], v[120:123], v[184:187]
  buffer_load_dwordx4 v3, s[28:31], 0 offen lds
  v_fmac_f32 v21, v47, v79
  v_mfma_f32_16x16x32_bf16 v[40:43], a[148:151], a[148:151], 0
  v_fmac_f32 v21, v36, v80
  v_fmac_f32 v21, v37, v81
  v_mfma_f32_16x16x32_bf16 v[180:183], v[140:143], v[116:119], v[180:183]
  v_fmac_f32 v21, v38, v82
  v_fmac_f32 v21, v39, v83
  v_mfma_f32_16x16x32_bf16 v[176:179], v[140:143], v[112:115], v[176:179]
  buffer_load_dwordx4 v[140:143], v4, s[32:35], s43 offen offset:3072 sc1
  v_mfma_f32_16x16x32_bf16 v[44:47], v[52:55], a[148:151], 0
  s_waitcnt vmcnt(12) lgkmcnt(3)
  v_fmac_f32 v21, v40, v84
  v_fmac_f32 v21, v41, v85
  v_mfma_f32_16x16x32_bf16 v[160:163], v[144:147], v[96:99], v[160:163]
  s_add_u32 s43, s43, 8192
  ds_read_b128 v[112:115], v5 offset:704
  ds_read_b128 v[116:119], v5 offset:17344
  v_mfma_f32_16x16x32_bf16 v[164:167], v[144:147], v[100:103], v[164:167]
  s_waitcnt lgkmcnt(2)
  ds_read_b128 v[120:123], v5 offset:33984
  ds_read_b128 v[124:127], v5 offset:50624
  v_mfma_f32_16x16x32_bf16 v[36:39], a[24:27], a[152:155], 0
  ds_read_b128 a[156:159], v8 offset:7280
  v_fmac_f32 v21, v42, v86
  v_mfma_f32_16x16x32_bf16 v[168:171], v[144:147], v[104:107], v[168:171]
  s_add_u32 m0, s44, 14560
  v_add_u32_dpp v2, v206, v1 quad_perm:[2,2,2,2] row_mask:0xf bank_mask:0xf
  v_fmac_f32 v21, v43, v87
  v_mfma_f32_16x16x32_bf16 v[172:175], v[144:147], v[108:111], v[172:175]
  buffer_load_dwordx4 v2, s[28:31], 0 offen lds
  buffer_load_dwordx4 v[144:147], v4, s[32:35], s62 offen offset:0 sc1
  v_fmac_f32 v21, v45, v90
  v_mfma_f32_16x16x32_bf16 v[40:43], a[88:91], a[152:155], 0
  s_waitcnt vmcnt(13)
  v_fmac_f32 v22, v36, v76
  v_fmac_f32 v22, v37, v77
  v_mfma_f32_16x16x32_bf16 v[188:191], v[148:151], v[108:111], v[188:191]
  v_xad_u32 v5, v7, 16, v11
  v_fmac_f32 v22, v38, v78
  v_mfma_f32_16x16x32_bf16 v[184:187], v[148:151], v[104:107], v[184:187]
  v_fmac_f32 v22, v39, v79
  v_fmac_f32 v22, v40, v80
  v_mfma_f32_16x16x32_bf16 v[44:47], a[152:155], a[152:155], 0
  v_fmac_f32 v22, v41, v81
  v_fmac_f32 v22, v42, v82
  v_mfma_f32_16x16x32_bf16 v[180:183], v[148:151], v[100:103], v[180:183]
  v_fmac_f32 v22, v43, v83
  v_mfma_f32_16x16x32_bf16 v[176:179], v[148:151], v[96:99], v[176:179]
  buffer_load_dwordx4 v[148:151], v4, s[32:35], s62 offen offset:1024 sc1
  v_mfma_f32_16x16x32_bf16 v[36:39], v[52:55], a[152:155], 0
  s_waitcnt vmcnt(12) lgkmcnt(3)
  v_fmac_f32 v22, v44, v84
  v_fmac_f32 v22, v45, v85
  v_mfma_f32_16x16x32_bf16 v[160:163], v[152:155], v[112:115], v[160:163]
  ds_read_b128 v[96:99], v5 offset:768
  ds_read_b128 v[100:103], v5 offset:17408
  v_mfma_f32_16x16x32_bf16 v[164:167], v[152:155], v[116:119], v[164:167]
  s_waitcnt lgkmcnt(2)
  ds_read_b128 v[104:107], v5 offset:34048
  ds_read_b128 v[108:111], v5 offset:50688
  v_mfma_f32_16x16x32_bf16 v[40:43], a[28:31], a[156:159], 0
  s_add_u32 m0, s44, 15600
  ds_read_b128 a[160:163], v8 offset:8320
  v_add_u32_dpp v3, v206, v1 quad_perm:[3,3,3,3] row_mask:0xf bank_mask:0xf
  v_mfma_f32_16x16x32_bf16 v[168:171], v[152:155], v[120:123], v[168:171]
  buffer_load_dwordx4 v3, s[28:31], 0 offen lds
  v_fmac_f32 v22, v46, v86
  v_mfma_f32_16x16x32_bf16 v[172:175], v[152:155], v[124:127], v[172:175]
  buffer_load_dwordx4 v[152:155], v4, s[32:35], s62 offen offset:2048 sc1
  v_fmac_f32 v22, v47, v87
  v_fmac_f32 v22, v38, v90
  v_mfma_f32_16x16x32_bf16 v[44:47], a[92:95], a[156:159], 0
  s_waitcnt vmcnt(12)
  v_fmac_f32 v23, v40, v76
  v_fmac_f32 v23, v41, v77
  v_mfma_f32_16x16x32_bf16 v[188:191], v[156:159], v[124:127], v[188:191]
  v_fmac_f32 v23, v42, v78
  v_fmac_f32 v23, v43, v79
  v_mfma_f32_16x16x32_bf16 v[184:187], v[156:159], v[120:123], v[184:187]
  v_mfma_f32_16x16x32_bf16 v[36:39], a[156:159], a[156:159], 0
  v_fmac_f32 v23, v44, v80
  v_fmac_f32 v23, v45, v81
  v_mfma_f32_16x16x32_bf16 v[180:183], v[156:159], v[116:119], v[180:183]
  v_fmac_f32 v23, v46, v82
  v_fmac_f32 v23, v47, v83
  v_mfma_f32_16x16x32_bf16 v[176:179], v[156:159], v[112:115], v[176:179]
  buffer_load_dwordx4 v[156:159], v4, s[32:35], s62 offen offset:3072 sc1
  v_mfma_f32_16x16x32_bf16 v[40:43], v[52:55], a[156:159], 0
  s_waitcnt vmcnt(11) lgkmcnt(3)
  v_fmac_f32 v23, v36, v84
  v_fmac_f32 v23, v37, v85
  v_mfma_f32_16x16x32_bf16 v[160:163], v[128:131], v[96:99], v[160:163]
  s_add_u32 s62, s62, 8192
  ds_read_b128 v[112:115], v5 offset:832
  ds_read_b128 v[116:119], v5 offset:17472
  v_mfma_f32_16x16x32_bf16 v[164:167], v[128:131], v[100:103], v[164:167]
  s_waitcnt lgkmcnt(2)
  ds_read_b128 v[120:123], v5 offset:34112
  ds_read_b128 v[124:127], v5 offset:50752
  v_mfma_f32_16x16x32_bf16 v[44:47], a[32:35], a[160:163], 0
  ds_read_b128 a[164:167], v8 offset:9360
  v_fmac_f32 v23, v38, v86
  v_mfma_f32_16x16x32_bf16 v[168:171], v[128:131], v[104:107], v[168:171]
  v_fmac_f32 v23, v39, v87
  v_fmac_f32 v23, v43, v90
  v_mfma_f32_16x16x32_bf16 v[172:175], v[128:131], v[108:111], v[172:175]
  buffer_load_dwordx4 v[128:131], v4, s[32:35], s43 offen offset:0 sc1
  v_mfma_f32_16x16x32_bf16 v[36:39], a[96:99], a[160:163], 0
  s_waitcnt vmcnt(10)
  v_fmac_f32 v24, v44, v76
  v_fmac_f32 v24, v45, v77
  v_mfma_f32_16x16x32_bf16 v[188:191], v[132:135], v[108:111], v[188:191]
  v_fmac_f32 v24, v46, v78
  v_fmac_f32 v24, v47, v79
  v_mfma_f32_16x16x32_bf16 v[184:187], v[132:135], v[104:107], v[184:187]
  v_mfma_f32_16x16x32_bf16 v[40:43], a[160:163], a[160:163], 0
  v_fmac_f32 v24, v36, v80
  v_fmac_f32 v24, v37, v81
  v_mfma_f32_16x16x32_bf16 v[180:183], v[132:135], v[100:103], v[180:183]
  v_fmac_f32 v24, v38, v82
  v_fmac_f32 v24, v39, v83
  v_mfma_f32_16x16x32_bf16 v[176:179], v[132:135], v[96:99], v[176:179]
  buffer_load_dwordx4 v[132:135], v4, s[32:35], s43 offen offset:1024 sc1
  v_mfma_f32_16x16x32_bf16 v[44:47], v[56:59], a[160:163], 0
  s_waitcnt vmcnt(10) lgkmcnt(3)
  v_fmac_f32 v24, v40, v84
  v_fmac_f32 v24, v41, v85
  v_mfma_f32_16x16x32_bf16 v[160:163], v[136:139], v[112:115], v[160:163]
  ds_read_b128 v[96:99], v5 offset:896
  ds_read_b128 v[100:103], v5 offset:17536
  v_mfma_f32_16x16x32_bf16 v[164:167], v[136:139], v[116:119], v[164:167]
  s_waitcnt lgkmcnt(2)
  ds_read_b128 v[104:107], v5 offset:34176
  ds_read_b128 v[108:111], v5 offset:50816
  v_mfma_f32_16x16x32_bf16 v[36:39], a[36:39], a[164:167], 0
  ds_read_b128 a[168:171], v8 offset:10400
  v_fmac_f32 v24, v42, v86
  v_mfma_f32_16x16x32_bf16 v[168:171], v[136:139], v[120:123], v[168:171]
  v_fmac_f32 v24, v43, v87
  v_fmac_f32 v24, v44, v90
  v_mfma_f32_16x16x32_bf16 v[172:175], v[136:139], v[124:127], v[172:175]
  buffer_load_dwordx4 v[136:139], v4, s[32:35], s43 offen offset:2048 sc1
  v_mfma_f32_16x16x32_bf16 v[40:43], a[100:103], a[164:167], 0
  s_waitcnt vmcnt(9)
  v_fmac_f32 v25, v36, v76
  v_fmac_f32 v25, v37, v77
  v_mfma_f32_16x16x32_bf16 v[188:191], v[140:143], v[124:127], v[188:191]
  v_fmac_f32 v25, v38, v78
  v_fmac_f32 v25, v39, v79
  v_mfma_f32_16x16x32_bf16 v[184:187], v[140:143], v[120:123], v[184:187]
  v_mfma_f32_16x16x32_bf16 v[44:47], a[164:167], a[164:167], 0
  v_fmac_f32 v25, v40, v80
  v_fmac_f32 v25, v41, v81
  v_mfma_f32_16x16x32_bf16 v[180:183], v[140:143], v[116:119], v[180:183]
  v_fmac_f32 v25, v42, v82
  v_fmac_f32 v25, v43, v83
  v_mfma_f32_16x16x32_bf16 v[176:179], v[140:143], v[112:115], v[176:179]
  buffer_load_dwordx4 v[140:143], v4, s[32:35], s43 offen offset:3072 sc1
  v_mfma_f32_16x16x32_bf16 v[36:39], v[56:59], a[164:167], 0
  s_waitcnt vmcnt(8) lgkmcnt(3)
  v_fmac_f32 v25, v44, v84
  v_fmac_f32 v25, v45, v85
  v_mfma_f32_16x16x32_bf16 v[160:163], v[144:147], v[96:99], v[160:163]
  s_add_u32 s43, s43, 8192
  ds_read_b128 v[112:115], v5 offset:960
  ds_read_b128 v[116:119], v5 offset:17600
  v_mfma_f32_16x16x32_bf16 v[164:167], v[144:147], v[100:103], v[164:167]
  s_waitcnt lgkmcnt(2)
  ds_read_b128 v[120:123], v5 offset:34240
  ds_read_b128 v[124:127], v5 offset:50880
  v_mfma_f32_16x16x32_bf16 v[40:43], a[40:43], a[168:171], 0
  ds_read_b128 a[172:175], v8 offset:11440
  v_fmac_f32 v25, v46, v86
  v_mfma_f32_16x16x32_bf16 v[168:171], v[144:147], v[104:107], v[168:171]
  v_fmac_f32 v25, v47, v87
  v_fmac_f32 v25, v37, v90
  v_mfma_f32_16x16x32_bf16 v[172:175], v[144:147], v[108:111], v[172:175]
  buffer_load_dwordx4 v[144:147], v4, s[32:35], s62 offen offset:0 sc1
  v_mfma_f32_16x16x32_bf16 v[44:47], a[104:107], a[168:171], 0
  s_waitcnt vmcnt(8)
  v_fmac_f32 v26, v40, v76
  v_fmac_f32 v26, v41, v77
  v_mfma_f32_16x16x32_bf16 v[188:191], v[148:151], v[108:111], v[188:191]
  v_subrev_u32 v11, 66560, v11
  v_xad_u32 v5, v7, 0, v11
  v_mfma_f32_16x16x32_bf16 v[184:187], v[148:151], v[104:107], v[184:187]
  v_fmac_f32 v26, v42, v78
  v_fmac_f32 v26, v43, v79
  v_mfma_f32_16x16x32_bf16 v[36:39], a[168:171], a[168:171], 0
  v_fmac_f32 v26, v44, v80
  v_fmac_f32 v26, v45, v81
  v_mfma_f32_16x16x32_bf16 v[180:183], v[148:151], v[100:103], v[180:183]
  v_fmac_f32 v26, v46, v82
  v_fmac_f32 v26, v47, v83
  v_mfma_f32_16x16x32_bf16 v[176:179], v[148:151], v[96:99], v[176:179]
  buffer_load_dwordx4 v[148:151], v4, s[32:35], s62 offen offset:1024 sc1
  v_mfma_f32_16x16x32_bf16 v[40:43], v[56:59], a[168:171], 0
  s_waitcnt vmcnt(7) lgkmcnt(1)
  s_barrier
  v_fmac_f32 v26, v36, v84
  v_fmac_f32 v26, v37, v85
  v_mfma_f32_16x16x32_bf16 v[160:163], v[152:155], v[112:115], v[160:163]
  ds_read_b128 v[96:99], v5 offset:0
  ds_read_b128 v[100:103], v5 offset:16640
  v_mfma_f32_16x16x32_bf16 v[164:167], v[152:155], v[116:119], v[164:167]
  s_waitcnt lgkmcnt(2)
  ds_read_b128 v[104:107], v5 offset:33280
  ds_read_b128 v[108:111], v5 offset:49920
  v_mfma_f32_16x16x32_bf16 v[44:47], a[44:47], a[172:175], 0
  s_add_u32 m0, s44, 66560
  v_xor_b32 v8, 16, v8
  ds_read_b128 a[176:179], v8 offset:12480
  v_add_u32_dpp v2, v195, v1 quad_perm:[0,0,0,0] row_mask:0xf bank_mask:0xf
  v_mfma_f32_16x16x32_bf16 v[168:171], v[152:155], v[120:123], v[168:171]
  buffer_load_dwordx4 v2, s[28:31], 0 offen lds
  v_fmac_f32 v26, v38, v86
  v_mfma_f32_16x16x32_bf16 v[172:175], v[152:155], v[124:127], v[172:175]
  buffer_load_dwordx4 v[152:155], v4, s[32:35], s62 offen offset:2048 sc1
  v_fmac_f32 v26, v39, v87
  v_fmac_f32 v26, v42, v90
  v_mfma_f32_16x16x32_bf16 v[36:39], a[108:111], a[172:175], 0
  s_waitcnt vmcnt(8)
  v_fmac_f32 v27, v44, v76
  v_fmac_f32 v27, v45, v77
  v_mfma_f32_16x16x32_bf16 v[188:191], v[156:159], v[124:127], v[188:191]
  v_fmac_f32 v27, v46, v78
  v_fmac_f32 v27, v47, v79
  v_mfma_f32_16x16x32_bf16 v[184:187], v[156:159], v[120:123], v[184:187]
  v_mfma_f32_16x16x32_bf16 v[40:43], a[172:175], a[172:175], 0
  v_fmac_f32 v27, v36, v80
  v_fmac_f32 v27, v37, v81
  v_mfma_f32_16x16x32_bf16 v[180:183], v[156:159], v[116:119], v[180:183]
  v_fmac_f32 v27, v38, v82
  v_fmac_f32 v27, v39, v83
  v_mfma_f32_16x16x32_bf16 v[176:179], v[156:159], v[112:115], v[176:179]
  s_add_u32 m0, s44, 67600
  buffer_load_dwordx4 v[156:159], v4, s[32:35], s62 offen offset:3072 sc1
  v_add_u32_dpp v3, v195, v1 quad_perm:[1,1,1,1] row_mask:0xf bank_mask:0xf
  v_fmac_f32 v27, v40, v84
  v_mfma_f32_16x16x32_bf16 v[44:47], v[56:59], a[172:175], 0
  s_waitcnt vmcnt(8) lgkmcnt(3)
  buffer_load_dwordx4 v3, s[28:31], 0 offen lds
  v_fmac_f32 v27, v41, v85
  v_mfma_f32_16x16x32_bf16 v[160:163], v[128:131], v[96:99], v[160:163]
  s_add_u32 s62, s62, 8192
  ds_read_b128 v[112:115], v5 offset:64
  ds_read_b128 v[116:119], v5 offset:16704
  v_mfma_f32_16x16x32_bf16 v[164:167], v[128:131], v[100:103], v[164:167]
  s_waitcnt lgkmcnt(2)
  ds_read_b128 v[120:123], v5 offset:33344
  ds_read_b128 v[124:127], v5 offset:49984
  v_mfma_f32_16x16x32_bf16 v[36:39], a[48:51], a[176:179], 0
  ds_read_b128 a[180:183], v8 offset:13520
  v_fmac_f32 v27, v42, v86
  v_mfma_f32_16x16x32_bf16 v[168:171], v[128:131], v[104:107], v[168:171]
  v_fmac_f32 v27, v43, v87
  v_fmac_f32 v27, v47, v90
  v_mfma_f32_16x16x32_bf16 v[172:175], v[128:131], v[108:111], v[172:175]
  buffer_load_dwordx4 v[128:131], v4, s[32:35], s43 offen offset:0 sc1
  v_mfma_f32_16x16x32_bf16 v[40:43], a[112:115], a[176:179], 0
  s_waitcnt vmcnt(9)
  v_fmac_f32 v28, v36, v76
  v_fmac_f32 v28, v37, v77
  v_mfma_f32_16x16x32_bf16 v[188:191], v[132:135], v[108:111], v[188:191]
  v_fmac_f32 v28, v38, v78
  v_fmac_f32 v28, v39, v79
  v_mfma_f32_16x16x32_bf16 v[184:187], v[132:135], v[104:107], v[184:187]
  s_add_u32 m0, s44, 68640
  v_add_u32_dpp v2, v195, v1 quad_perm:[2,2,2,2] row_mask:0xf bank_mask:0xf
  v_fmac_f32 v28, v40, v80
  v_mfma_f32_16x16x32_bf16 v[44:47], a[176:179], a[176:179], 0
  buffer_load_dwordx4 v2, s[28:31], 0 offen lds
  v_fmac_f32 v28, v41, v81
  v_mfma_f32_16x16x32_bf16 v[180:183], v[132:135], v[100:103], v[180:183]
  v_fmac_f32 v28, v42, v82
  v_fmac_f32 v28, v43, v83
  v_mfma_f32_16x16x32_bf16 v[176:179], v[132:135], v[96:99], v[176:179]
  buffer_load_dwordx4 v[132:135], v4, s[32:35], s43 offen offset:1024 sc1
  v_mfma_f32_16x16x32_bf16 v[36:39], v[60:63], a[176:179], 0
  s_waitcnt vmcnt(10) lgkmcnt(3)
  v_fmac_f32 v28, v44, v84
  v_fmac_f32 v28, v45, v85
  v_mfma_f32_16x16x32_bf16 v[160:163], v[136:139], v[112:115], v[160:163]
  ds_read_b128 v[96:99], v5 offset:128
  ds_read_b128 v[100:103], v5 offset:16768
  v_mfma_f32_16x16x32_bf16 v[164:167], v[136:139], v[116:119], v[164:167]
  s_waitcnt lgkmcnt(2)
  ds_read_b128 v[104:107], v5 offset:33408
  ds_read_b128 v[108:111], v5 offset:50048
  v_mfma_f32_16x16x32_bf16 v[40:43], a[52:55], a[180:183], 0
  ds_read_b128 a[184:187], v8 offset:14560
  v_fmac_f32 v28, v46, v86
  v_mfma_f32_16x16x32_bf16 v[168:171], v[136:139], v[120:123], v[168:171]
  v_fmac_f32 v28, v47, v87
  v_fmac_f32 v28, v36, v90
  v_mfma_f32_16x16x32_bf16 v[172:175], v[136:139], v[124:127], v[172:175]
  buffer_load_dwordx4 v[136:139], v4, s[32:35], s43 offen offset:2048 sc1
  v_mfma_f32_16x16x32_bf16 v[44:47], a[116:119], a[180:183], 0
  s_waitcnt vmcnt(10)
  v_fmac_f32 v29, v40, v76
  v_fmac_f32 v29, v41, v77
  v_mfma_f32_16x16x32_bf16 v[188:191], v[140:143], v[124:127], v[188:191]
  s_add_u32 m0, s44, 69680
  v_add_u32_dpp v3, v195, v1 quad_perm:[3,3,3,3] row_mask:0xf bank_mask:0xf
  v_fmac_f32 v29, v42, v78
  v_mfma_f32_16x16x32_bf16 v[184:187], v[140:143], v[120:123], v[184:187]
  buffer_load_dwordx4 v3, s[28:31], 0 offen lds
  v_fmac_f32 v29, v43, v79
  v_mfma_f32_16x16x32_bf16 v[36:39], a[180:183], a[180:183], 0
  v_fmac_f32 v29, v44, v80
  v_fmac_f32 v29, v45, v81
  v_mfma_f32_16x16x32_bf16 v[180:183], v[140:143], v[116:119], v[180:183]
  v_fmac_f32 v29, v46, v82
  v_fmac_f32 v29, v47, v83
  v_mfma_f32_16x16x32_bf16 v[176:179], v[140:143], v[112:115], v[176:179]
  buffer_load_dwordx4 v[140:143], v4, s[32:35], s43 offen offset:3072 sc1
  v_mfma_f32_16x16x32_bf16 v[40:43], v[60:63], a[180:183], 0
  s_waitcnt vmcnt(11) lgkmcnt(3)
  v_fmac_f32 v29, v36, v84
  v_fmac_f32 v29, v37, v85
  v_mfma_f32_16x16x32_bf16 v[160:163], v[144:147], v[96:99], v[160:163]
  s_add_u32 s43, s43, 8192
  ds_read_b128 v[112:115], v5 offset:192
  ds_read_b128 v[116:119], v5 offset:16832
  v_mfma_f32_16x16x32_bf16 v[164:167], v[144:147], v[100:103], v[164:167]
  s_waitcnt lgkmcnt(2)
  ds_read_b128 v[120:123], v5 offset:33472
  ds_read_b128 v[124:127], v5 offset:50112
  v_mfma_f32_16x16x32_bf16 v[44:47], a[56:59], a[184:187], 0
  ds_read_b128 a[188:191], v8 offset:15600
  v_fmac_f32 v29, v38, v86
  v_mfma_f32_16x16x32_bf16 v[168:171], v[144:147], v[104:107], v[168:171]
  s_add_u32 m0, s44, 70720
  v_add_u32_dpp v2, v199, v6 quad_perm:[0,0,0,0] row_mask:0xf bank_mask:0xf
  v_fmac_f32 v29, v39, v87
  v_mfma_f32_16x16x32_bf16 v[172:175], v[144:147], v[108:111], v[172:175]
  buffer_load_dwordx4 v2, s[28:31], 0 offen lds
  buffer_load_dwordx4 v[144:147], v4, s[32:35], s62 offen offset:0 sc1
  v_fmac_f32 v29, v41, v90
  v_mfma_f32_16x16x32_bf16 v[36:39], a[120:123], a[184:187], 0
  s_waitcnt vmcnt(12)
  v_fmac_f32 v30, v44, v76
  v_fmac_f32 v30, v45, v77
  v_mfma_f32_16x16x32_bf16 v[188:191], v[148:151], v[108:111], v[188:191]
  v_xad_u32 v5, v7, 48, v11
  v_fmac_f32 v30, v46, v78
  v_mfma_f32_16x16x32_bf16 v[184:187], v[148:151], v[104:107], v[184:187]
  v_fmac_f32 v30, v47, v79
  v_fmac_f32 v30, v36, v80
  v_mfma_f32_16x16x32_bf16 v[40:43], a[184:187], a[184:187], 0
  v_fmac_f32 v30, v37, v81
  v_fmac_f32 v30, v38, v82
  v_mfma_f32_16x16x32_bf16 v[180:183], v[148:151], v[100:103], v[180:183]
  v_fmac_f32 v30, v39, v83
  v_mfma_f32_16x16x32_bf16 v[176:179], v[148:151], v[96:99], v[176:179]
  buffer_load_dwordx4 v[148:151], v4, s[32:35], s62 offen offset:1024 sc1
  v_mfma_f32_16x16x32_bf16 v[44:47], v[60:63], a[184:187], 0
  s_waitcnt vmcnt(11) lgkmcnt(3)
  v_fmac_f32 v30, v40, v84
  v_fmac_f32 v30, v41, v85
  v_mfma_f32_16x16x32_bf16 v[160:163], v[152:155], v[112:115], v[160:163]
  ds_read_b128 v[96:99], v5 offset:256
  ds_read_b128 v[100:103], v5 offset:16896
  v_mfma_f32_16x16x32_bf16 v[164:167], v[152:155], v[116:119], v[164:167]
  s_waitcnt lgkmcnt(2)
  ds_read_b128 v[104:107], v5 offset:33536
  ds_read_b128 v[108:111], v5 offset:50176
  v_mfma_f32_16x16x32_bf16 v[36:39], a[60:63], a[188:191], 0
  s_add_u32 m0, s44, 71760
  ds_read_b128 a[192:195], v9 offset:0
  v_add_u32_dpp v3, v199, v6 quad_perm:[1,1,1,1] row_mask:0xf bank_mask:0xf
  v_mfma_f32_16x16x32_bf16 v[168:171], v[152:155], v[120:123], v[168:171]
  buffer_load_dwordx4 v3, s[28:31], 0 offen lds
  v_fmac_f32 v30, v42, v86
  v_mfma_f32_16x16x32_bf16 v[172:175], v[152:155], v[124:127], v[172:175]
  buffer_load_dwordx4 v[152:155], v4, s[32:35], s62 offen offset:2048 sc1
  v_fmac_f32 v30, v43, v87
  v_fmac_f32 v30, v46, v90
  v_mfma_f32_16x16x32_bf16 v[40:43], a[124:127], a[188:191], 0
  s_waitcnt vmcnt(12)
  v_fmac_f32 v31, v36, v76
  v_fmac_f32 v31, v37, v77
  v_mfma_f32_16x16x32_bf16 v[188:191], v[156:159], v[124:127], v[188:191]
  v_fmac_f32 v31, v38, v78
  v_fmac_f32 v31, v39, v79
  v_mfma_f32_16x16x32_bf16 v[184:187], v[156:159], v[120:123], v[184:187]
  ds_read_b128 v[76:79], v10 offset:12288
  v_fmac_f32 v31, v40, v80
  v_mfma_f32_16x16x32_bf16 v[44:47], a[188:191], a[188:191], 0
  v_fmac_f32 v31, v41, v81
  v_fmac_f32 v31, v42, v82
  v_mfma_f32_16x16x32_bf16 v[180:183], v[156:159], v[116:119], v[180:183]
  v_fmac_f32 v31, v43, v83
  v_mfma_f32_16x16x32_bf16 v[176:179], v[156:159], v[112:115], v[176:179]
  s_add_u32 m0, s44, 72800
  buffer_load_dwordx4 v[156:159], v4, s[32:35], s62 offen offset:3072 sc1
  ds_read_b128 v[80:83], v10 offset:13312
  v_add_u32_dpp v2, v199, v6 quad_perm:[2,2,2,2] row_mask:0xf bank_mask:0xf
  v_mfma_f32_16x16x32_bf16 v[36:39], v[60:63], a[188:191], 0
  s_waitcnt vmcnt(11) lgkmcnt(5)
  buffer_load_dwordx4 v2, s[28:31], 0 offen lds
  v_fmac_f32 v31, v44, v84
  v_mfma_f32_16x16x32_bf16 v[160:163], v[128:131], v[96:99], v[160:163]
  s_waitcnt lgkmcnt(2)
  ds_read_b128 v[112:115], v5 offset:320
  ds_read_b128 v[116:119], v5 offset:16960
  v_mfma_f32_16x16x32_bf16 v[40:43], a[0:3], a[192:195], 0
  s_add_u32 s62, s62, 8192
  ds_read_b128 v[120:123], v5 offset:33600
  ds_read_b128 v[124:127], v5 offset:50240
  v_mfma_f32_16x16x32_bf16 v[164:167], v[128:131], v[100:103], v[164:167]
  ds_read_b128 a[196:199], v9 offset:1040
  v_fmac_f32 v31, v45, v85
  v_mfma_f32_16x16x32_bf16 v[168:171], v[128:131], v[104:107], v[168:171]
  v_fmac_f32 v31, v46, v86
  v_fmac_f32 v31, v47, v87
  v_mfma_f32_16x16x32_bf16 v[44:47], a[64:67], a[192:195], 0
  ds_read_b128 v[84:87], v10 offset:14336
  v_fmac_f32 v31, v39, v90
  v_mfma_f32_16x16x32_bf16 v[172:175], v[128:131], v[108:111], v[172:175]
  s_waitcnt vmcnt(10)
  buffer_load_dwordx4 v[128:131], v4, s[32:35], s43 offen offset:0 sc1
  v_fmac_f32 v16, v40, v64
  v_fmac_f32 v16, v41, v65
  v_mfma_f32_16x16x32_bf16 v[188:191], v[132:135], v[108:111], v[188:191]
  v_fmac_f32 v16, v42, v66
  v_fmac_f32 v16, v43, v67
  v_mfma_f32_16x16x32_bf16 v[36:39], a[128:131], a[192:195], 0
  v_fmac_f32 v16, v44, v68
  v_fmac_f32 v16, v45, v69
  v_mfma_f32_16x16x32_bf16 v[184:187], v[132:135], v[104:107], v[184:187]
  s_add_u32 m0, s44, 73840
  v_add_u32_dpp v3, v199, v6 quad_perm:[3,3,3,3] row_mask:0xf bank_mask:0xf
  v_fmac_f32 v16, v46, v70
  v_mfma_f32_16x16x32_bf16 v[40:43], a[192:195], a[192:195], 0
  buffer_load_dwordx4 v3, s[28:31], 0 offen lds
  v_fmac_f32 v16, v47, v71
  v_mfma_f32_16x16x32_bf16 v[180:183], v[132:135], v[100:103], v[180:183]
  v_fmac_f32 v16, v36, v72
  v_fmac_f32 v16, v37, v73
  v_mfma_f32_16x16x32_bf16 v[176:179], v[132:135], v[96:99], v[176:179]
  buffer_load_dwordx4 v[132:135], v4, s[32:35], s43 offen offset:1024 sc1
  v_fmac_f32 v16, v38, v74
  v_fmac_f32 v16, v39, v75
  v_mfma_f32_16x16x32_bf16 v[44:47], v[48:51], a[192:195], 0
  s_waitcnt vmcnt(12) lgkmcnt(4)
  v_fmac_f32 v16, v40, v76
  v_fmac_f32 v16, v41, v77
  v_mfma_f32_16x16x32_bf16 v[160:163], v[136:139], v[112:115], v[160:163]
  s_waitcnt lgkmcnt(1)
  ds_read_b128 v[96:99], v5 offset:384
  ds_read_b128 v[100:103], v5 offset:17024
  v_mfma_f32_16x16x32_bf16 v[36:39], a[4:7], a[196:199], 0
  ds_read_b128 v[104:107], v5 offset:33664
  ds_read_b128 v[108:111], v5 offset:50304
  v_mfma_f32_16x16x32_bf16 v[164:167], v[136:139], v[116:119], v[164:167]
  ds_read_b128 a[200:203], v9 offset:2080
  v_fmac_f32 v16, v42, v78
  v_mfma_f32_16x16x32_bf16 v[168:171], v[136:139], v[120:123], v[168:171]
  v_fmac_f32 v16, v43, v79
  v_fmac_f32 v16, v44, v91
  v_mfma_f32_16x16x32_bf16 v[40:43], a[68:71], a[196:199], 0
  v_fmac_f32 v17, v36, v64
  v_fmac_f32 v17, v37, v65
  v_mfma_f32_16x16x32_bf16 v[172:175], v[136:139], v[124:127], v[172:175]
  s_waitcnt vmcnt(10)
  buffer_load_dwordx4 v[136:139], v4, s[32:35], s43 offen offset:2048 sc1
  v_fmac_f32 v17, v38, v66
  v_fmac_f32 v17, v39, v67
  v_mfma_f32_16x16x32_bf16 v[188:191], v[140:143], v[124:127], v[188:191]
  s_add_u32 m0, s44, 74880
  v_add_u32_dpp v2, v203, v6 quad_perm:[0,0,0,0] row_mask:0xf bank_mask:0xf
  v_fmac_f32 v17, v40, v68
  v_mfma_f32_16x16x32_bf16 v[44:47], a[132:135], a[196:199], 0
  buffer_load_dwordx4 v2, s[28:31], 0 offen lds
  v_fmac_f32 v17, v41, v69
  v_mfma_f32_16x16x32_bf16 v[184:187], v[140:143], v[120:123], v[184:187]
  v_fmac_f32 v17, v42, v70
  v_fmac_f32 v17, v43, v71
  v_mfma_f32_16x16x32_bf16 v[36:39], a[196:199], a[196:199], 0
  v_mfma_f32_16x16x32_bf16 v[180:183], v[140:143], v[116:119], v[180:183]
  v_mfma_f32_16x16x32_bf16 v[176:179], v[140:143], v[112:115], v[176:179]
  buffer_load_dwordx4 v[140:143], v4, s[32:35], s43 offen offset:3072 sc1
  v_fmac_f32 v17, v44, v72
  v_fmac_f32 v17, v45, v73
  v_mfma_f32_16x16x32_bf16 v[40:43], v[48:51], a[196:199], 0
  s_waitcnt vmcnt(11) lgkmcnt(3)
  v_fmac_f32 v17, v46, v74
  v_fmac_f32 v17, v47, v75
  v_mfma_f32_16x16x32_bf16 v[160:163], v[144:147], v[96:99], v[160:163]
  s_waitcnt lgkmcnt(0)
  ds_read_b128 v[112:115], v5 offset:448
  ds_read_b128 v[116:119], v5 offset:17088
  v_mfma_f32_16x16x32_bf16 v[44:47], a[8:11], a[200:203], 0
  s_add_u32 s43, s43, 8192
  ds_read_b128 v[120:123], v5 offset:33728
  ds_read_b128 v[124:127], v5 offset:50368
  v_mfma_f32_16x16x32_bf16 v[164:167], v[144:147], v[100:103], v[164:167]
  ds_read_b128 a[204:207], v9 offset:3120
  v_fmac_f32 v17, v36, v76
  v_mfma_f32_16x16x32_bf16 v[168:171], v[144:147], v[104:107], v[168:171]
  s_add_u32 m0, s44, 75920
  v_add_u32_dpp v3, v203, v6 quad_perm:[1,1,1,1] row_mask:0xf bank_mask:0xf
  v_fmac_f32 v17, v37, v77
  v_fmac_f32 v17, v38, v78
  v_fmac_f32 v17, v39, v79
  v_mfma_f32_16x16x32_bf16 v[36:39], a[72:75], a[200:203], 0
  buffer_load_dwordx4 v3, s[28:31], 0 offen lds
  v_fmac_f32 v17, v41, v91
  v_mfma_f32_16x16x32_bf16 v[172:175], v[144:147], v[108:111], v[172:175]
  s_waitcnt vmcnt(11)
  buffer_load_dwordx4 v[144:147], v4, s[32:35], s62 offen offset:0 sc1
  v_fmac_f32 v18, v44, v64
  v_fmac_f32 v18, v45, v65
  v_mfma_f32_16x16x32_bf16 v[188:191], v[148:151], v[108:111], v[188:191]
  v_xad_u32 v5, v7, 32, v11
  v_fmac_f32 v18, v46, v66
  v_mfma_f32_16x16x32_bf16 v[40:43], a[136:139], a[200:203], 0
  v_fmac_f32 v18, v47, v67
  v_fmac_f32 v18, v36, v68
  v_mfma_f32_16x16x32_bf16 v[184:187], v[148:151], v[104:107], v[184:187]
  v_fmac_f32 v18, v37, v69
  v_fmac_f32 v18, v38, v70
  v_mfma_f32_16x16x32_bf16 v[44:47], a[200:203], a[200:203], 0
  v_fmac_f32 v18, v39, v71
  v_mfma_f32_16x16x32_bf16 v[180:183], v[148:151], v[100:103], v[180:183]
  v_fmac_f32 v18, v40, v72
  v_fmac_f32 v18, v41, v73
  v_mfma_f32_16x16x32_bf16 v[176:179], v[148:151], v[96:99], v[176:179]
  buffer_load_dwordx4 v[148:151], v4, s[32:35], s62 offen offset:1024 sc1
  v_fmac_f32 v18, v42, v74
  v_fmac_f32 v18, v43, v75
  v_mfma_f32_16x16x32_bf16 v[36:39], v[48:51], a[200:203], 0
  s_waitcnt vmcnt(11) lgkmcnt(3)
  v_fmac_f32 v18, v44, v76
  v_fmac_f32 v18, v45, v77
  v_mfma_f32_16x16x32_bf16 v[160:163], v[152:155], v[112:115], v[160:163]
  s_waitcnt lgkmcnt(0)
  ds_read_b128 v[96:99], v5 offset:512
  ds_read_b128 v[100:103], v5 offset:17152
  v_mfma_f32_16x16x32_bf16 v[40:43], a[12:15], a[204:207], 0
  s_add_u32 m0, s44, 76960
  ds_read_b128 v[104:107], v5 offset:33792
  ds_read_b128 v[108:111], v5 offset:50432
  v_mfma_f32_16x16x32_bf16 v[164:167], v[152:155], v[116:119], v[164:167]
  v_xor_b32 v9, 16, v9
  ds_read_b128 a[208:211], v9 offset:4160
  v_add_u32_dpp v2, v203, v6 quad_perm:[2,2,2,2] row_mask:0xf bank_mask:0xf
  v_mfma_f32_16x16x32_bf16 v[168:171], v[152:155], v[120:123], v[168:171]
  buffer_load_dwordx4 v2, s[28:31], 0 offen lds
  v_fmac_f32 v18, v46, v78
  v_fmac_f32 v18, v47, v79
  v_mfma_f32_16x16x32_bf16 v[44:47], a[76:79], a[204:207], 0
  v_fmac_f32 v18, v38, v91
  v_fmac_f32 v19, v40, v64
  v_mfma_f32_16x16x32_bf16 v[172:175], v[152:155], v[124:127], v[172:175]
  s_waitcnt vmcnt(11)
  buffer_load_dwordx4 v[152:155], v4, s[32:35], s62 offen offset:2048 sc1
  v_fmac_f32 v19, v41, v65
  v_fmac_f32 v19, v42, v66
  v_mfma_f32_16x16x32_bf16 v[188:191], v[156:159], v[124:127], v[188:191]
  v_fmac_f32 v19, v43, v67
  v_fmac_f32 v19, v44, v68
  v_mfma_f32_16x16x32_bf16 v[36:39], a[140:143], a[204:207], 0
  v_fmac_f32 v19, v45, v69
  v_fmac_f32 v19, v46, v70
  v_mfma_f32_16x16x32_bf16 v[184:187], v[156:159], v[120:123], v[184:187]
  v_fmac_f32 v19, v47, v71
  v_mfma_f32_16x16x32_bf16 v[40:43], a[204:207], a[204:207], 0
  v_mfma_f32_16x16x32_bf16 v[180:183], v[156:159], v[116:119], v[180:183]
  v_mfma_f32_16x16x32_bf16 v[176:179], v[156:159], v[112:115], v[176:179]
  s_add_u32 m0, s44, 78000
  buffer_load_dwordx4 v[156:159], v4, s[32:35], s62 offen offset:3072 sc1
  v_add_u32_dpp v3, v203, v6 quad_perm:[3,3,3,3] row_mask:0xf bank_mask:0xf
  v_fmac_f32 v19, v36, v72
  v_mfma_f32_16x16x32_bf16 v[44:47], v[48:51], a[204:207], 0
  s_waitcnt vmcnt(11) lgkmcnt(3)
  buffer_load_dwordx4 v3, s[28:31], 0 offen lds
  v_fmac_f32 v19, v37, v73
  v_mfma_f32_16x16x32_bf16 v[160:163], v[128:131], v[96:99], v[160:163]
  s_waitcnt lgkmcnt(0)
  ds_read_b128 v[112:115], v5 offset:576
  ds_read_b128 v[116:119], v5 offset:17216
  v_fmac_f32 v19, v38, v74
  v_fmac_f32 v19, v39, v75
  v_mfma_f32_16x16x32_bf16 v[36:39], a[16:19], a[208:211], 0
  s_add_u32 s62, s62, 8192
  ds_read_b128 v[120:123], v5 offset:33856
  ds_read_b128 v[124:127], v5 offset:50496
  v_mfma_f32_16x16x32_bf16 v[164:167], v[128:131], v[100:103], v[164:167]
  ds_read_b128 a[212:215], v9 offset:5200
  v_fmac_f32 v19, v40, v76
  v_mfma_f32_16x16x32_bf16 v[168:171], v[128:131], v[104:107], v[168:171]
  v_fmac_f32 v19, v41, v77
  v_fmac_f32 v19, v42, v78
  v_fmac_f32 v19, v43, v79
  v_mfma_f32_16x16x32_bf16 v[40:43], a[80:83], a[208:211], 0
  v_fmac_f32 v19, v47, v91
  v_fmac_f32 v20, v36, v64
  v_mfma_f32_16x16x32_bf16 v[172:175], v[128:131], v[108:111], v[172:175]
  s_waitcnt vmcnt(10)
  buffer_load_dwordx4 v[128:131], v4, s[32:35], s43 offen offset:0 sc1
  v_fmac_f32 v20, v37, v65
  v_fmac_f32 v20, v38, v66
  v_mfma_f32_16x16x32_bf16 v[188:191], v[132:135], v[108:111], v[188:191]
  v_fmac_f32 v20, v39, v67
  v_fmac_f32 v20, v40, v68
  v_mfma_f32_16x16x32_bf16 v[44:47], a[144:147], a[208:211], 0
  v_fmac_f32 v20, v41, v69
  v_fmac_f32 v20, v42, v70
  v_mfma_f32_16x16x32_bf16 v[184:187], v[132:135], v[104:107], v[184:187]
  s_add_u32 m0, s44, 79040
  v_add_u32_dpp v2, v207, v1 quad_perm:[0,0,0,0] row_mask:0xf bank_mask:0xf
  v_fmac_f32 v20, v43, v71
  v_mfma_f32_16x16x32_bf16 v[36:39], a[208:211], a[208:211], 0
  buffer_load_dwordx4 v2, s[28:31], 0 offen lds
  v_fmac_f32 v20, v44, v72
  v_mfma_f32_16x16x32_bf16 v[180:183], v[132:135], v[100:103], v[180:183]
  v_fmac_f32 v20, v45, v73
  v_fmac_f32 v20, v46, v74
  v_mfma_f32_16x16x32_bf16 v[176:179], v[132:135], v[96:99], v[176:179]
  buffer_load_dwordx4 v[132:135], v4, s[32:35], s43 offen offset:1024 sc1
  v_fmac_f32 v20, v47, v75
  v_fmac_f32 v20, v36, v76
  v_mfma_f32_16x16x32_bf16 v[40:43], v[52:55], a[208:211], 0
  s_waitcnt vmcnt(12) lgkmcnt(3)
  v_fmac_f32 v20, v37, v77
  v_fmac_f32 v20, v38, v78
  v_mfma_f32_16x16x32_bf16 v[160:163], v[136:139], v[112:115], v[160:163]
  s_waitcnt lgkmcnt(0)
  ds_read_b128 v[96:99], v5 offset:640
  ds_read_b128 v[100:103], v5 offset:17280
  v_mfma_f32_16x16x32_bf16 v[44:47], a[20:23], a[212:215], 0
  ds_read_b128 v[104:107], v5 offset:33920
  ds_read_b128 v[108:111], v5 offset:50560
  v_mfma_f32_16x16x32_bf16 v[164:167], v[136:139], v[116:119], v[164:167]
  ds_read_b128 a[216:219], v9 offset:6240
  v_fmac_f32 v20, v39, v79
  v_mfma_f32_16x16x32_bf16 v[168:171], v[136:139], v[120:123], v[168:171]
  v_fmac_f32 v20, v40, v91
  v_mfma_f32_16x16x32_bf16 v[36:39], a[84:87], a[212:215], 0
  v_fmac_f32 v21, v44, v64
  v_fmac_f32 v21, v45, v65
  v_mfma_f32_16x16x32_bf16 v[172:175], v[136:139], v[124:127], v[172:175]
  s_waitcnt vmcnt(10)
  buffer_load_dwordx4 v[136:139], v4, s[32:35], s43 offen offset:2048 sc1
  v_fmac_f32 v21, v46, v66
  v_fmac_f32 v21, v47, v67
  v_mfma_f32_16x16x32_bf16 v[188:191], v[140:143], v[124:127], v[188:191]
  s_add_u32 m0, s44, 80080
  v_add_u32_dpp v3, v207, v1 quad_perm:[1,1,1,1] row_mask:0xf bank_mask:0xf
  v_fmac_f32 v21, v36, v68
  v_mfma_f32_16x16x32_bf16 v[40:43], a[148:151], a[212:215], 0
  buffer_load_dwordx4 v3, s[28:31], 0 offen lds
  v_fmac_f32 v21, v37, v69
  v_mfma_f32_16x16x32_bf16 v[184:187], v[140:143], v[120:123], v[184:187]
  v_fmac_f32 v21, v38, v70
  v_fmac_f32 v21, v39, v71
  v_mfma_f32_16x16x32_bf16 v[44:47], a[212:215], a[212:215], 0
  v_mfma_f32_16x16x32_bf16 v[180:183], v[140:143], v[116:119], v[180:183]
  v_mfma_f32_16x16x32_bf16 v[176:179], v[140:143], v[112:115], v[176:179]
  buffer_load_dwordx4 v[140:143], v4, s[32:35], s43 offen offset:3072 sc1
  v_fmac_f32 v21, v40, v72
  v_fmac_f32 v21, v41, v73
  v_mfma_f32_16x16x32_bf16 v[36:39], v[52:55], a[212:215], 0
  s_waitcnt vmcnt(11) lgkmcnt(3)
  v_fmac_f32 v21, v42, v74
  v_fmac_f32 v21, v43, v75
  v_mfma_f32_16x16x32_bf16 v[160:163], v[144:147], v[96:99], v[160:163]
  s_waitcnt lgkmcnt(0)
  ds_read_b128 v[112:115], v5 offset:704
  ds_read_b128 v[116:119], v5 offset:17344
  v_mfma_f32_16x16x32_bf16 v[40:43], a[24:27], a[216:219], 0
  s_add_u32 s43, s43, 8192
  ds_read_b128 v[120:123], v5 offset:33984
  ds_read_b128 v[124:127], v5 offset:50624
  v_mfma_f32_16x16x32_bf16 v[164:167], v[144:147], v[100:103], v[164:167]
  ds_read_b128 a[220:223], v9 offset:7280
  v_fmac_f32 v21, v44, v76
  v_mfma_f32_16x16x32_bf16 v[168:171], v[144:147], v[104:107], v[168:171]
  s_add_u32 m0, s44, 81120
  v_add_u32_dpp v2, v207, v1 quad_perm:[2,2,2,2] row_mask:0xf bank_mask:0xf
  v_fmac_f32 v21, v45, v77
  v_fmac_f32 v21, v46, v78
  v_fmac_f32 v21, v47, v79
  v_mfma_f32_16x16x32_bf16 v[44:47], a[88:91], a[216:219], 0
  buffer_load_dwordx4 v2, s[28:31], 0 offen lds
  v_fmac_f32 v21, v37, v91
  v_mfma_f32_16x16x32_bf16 v[172:175], v[144:147], v[108:111], v[172:175]
  s_waitcnt vmcnt(11)
  buffer_load_dwordx4 v[144:147], v4, s[32:35], s62 offen offset:0 sc1
  v_fmac_f32 v22, v40, v64
  v_fmac_f32 v22, v41, v65
  v_mfma_f32_16x16x32_bf16 v[188:191], v[148:151], v[108:111], v[188:191]
  v_xad_u32 v5, v7, 16, v11
  v_fmac_f32 v22, v42, v66
  v_mfma_f32_16x16x32_bf16 v[36:39], a[152:155], a[216:219], 0
  v_fmac_f32 v22, v43, v67
  v_fmac_f32 v22, v44, v68
  v_mfma_f32_16x16x32_bf16 v[184:187], v[148:151], v[104:107], v[184:187]
  v_fmac_f32 v22, v45, v69
  v_fmac_f32 v22, v46, v70
  v_mfma_f32_16x16x32_bf16 v[40:43], a[216:219], a[216:219], 0
  v_fmac_f32 v22, v47, v71
  v_mfma_f32_16x16x32_bf16 v[180:183], v[148:151], v[100:103], v[180:183]
  v_fmac_f32 v22, v36, v72
  v_fmac_f32 v22, v37, v73
  v_mfma_f32_16x16x32_bf16 v[176:179], v[148:151], v[96:99], v[176:179]
  buffer_load_dwordx4 v[148:151], v4, s[32:35], s62 offen offset:1024 sc1
  v_fmac_f32 v22, v38, v74
  v_fmac_f32 v22, v39, v75
  v_mfma_f32_16x16x32_bf16 v[44:47], v[52:55], a[216:219], 0
  s_waitcnt vmcnt(11) lgkmcnt(3)
  v_fmac_f32 v22, v40, v76
  v_fmac_f32 v22, v41, v77
  v_mfma_f32_16x16x32_bf16 v[160:163], v[152:155], v[112:115], v[160:163]
  s_waitcnt lgkmcnt(0)
  ds_read_b128 v[96:99], v5 offset:768
  ds_read_b128 v[100:103], v5 offset:17408
  v_mfma_f32_16x16x32_bf16 v[36:39], a[28:31], a[220:223], 0
  s_add_u32 m0, s44, 82160
  ds_read_b128 v[104:107], v5 offset:34048
  ds_read_b128 v[108:111], v5 offset:50688
  v_mfma_f32_16x16x32_bf16 v[164:167], v[152:155], v[116:119], v[164:167]
  ds_read_b128 a[224:227], v9 offset:8320
  v_add_u32_dpp v3, v207, v1 quad_perm:[3,3,3,3] row_mask:0xf bank_mask:0xf
  v_mfma_f32_16x16x32_bf16 v[168:171], v[152:155], v[120:123], v[168:171]
  buffer_load_dwordx4 v3, s[28:31], 0 offen lds
  v_fmac_f32 v22, v42, v78
  v_fmac_f32 v22, v43, v79
  v_mfma_f32_16x16x32_bf16 v[40:43], a[92:95], a[220:223], 0
  v_fmac_f32 v22, v46, v91
  v_fmac_f32 v23, v36, v64
  v_mfma_f32_16x16x32_bf16 v[172:175], v[152:155], v[124:127], v[172:175]
  s_waitcnt vmcnt(11)
  buffer_load_dwordx4 v[152:155], v4, s[32:35], s62 offen offset:2048 sc1
  v_fmac_f32 v23, v37, v65
  v_fmac_f32 v23, v38, v66
  v_mfma_f32_16x16x32_bf16 v[188:191], v[156:159], v[124:127], v[188:191]
  v_fmac_f32 v23, v39, v67
  v_fmac_f32 v23, v40, v68
  v_mfma_f32_16x16x32_bf16 v[44:47], a[156:159], a[220:223], 0
  v_fmac_f32 v23, v41, v69
  v_fmac_f32 v23, v42, v70
  v_mfma_f32_16x16x32_bf16 v[184:187], v[156:159], v[120:123], v[184:187]
  v_fmac_f32 v23, v43, v71
  v_mfma_f32_16x16x32_bf16 v[36:39], a[220:223], a[220:223], 0
  v_mfma_f32_16x16x32_bf16 v[180:183], v[156:159], v[116:119], v[180:183]
  v_mfma_f32_16x16x32_bf16 v[176:179], v[156:159], v[112:115], v[176:179]
  buffer_load_dwordx4 v[156:159], v4, s[32:35], s62 offen offset:3072 sc1
  v_fmac_f32 v23, v44, v72
  v_fmac_f32 v23, v45, v73
  v_mfma_f32_16x16x32_bf16 v[40:43], v[52:55], a[220:223], 0
  s_waitcnt vmcnt(11) lgkmcnt(3)
  v_fmac_f32 v23, v46, v74
  v_fmac_f32 v23, v47, v75
  v_mfma_f32_16x16x32_bf16 v[160:163], v[128:131], v[96:99], v[160:163]
  s_waitcnt lgkmcnt(0)
  ds_read_b128 v[112:115], v5 offset:832
  ds_read_b128 v[116:119], v5 offset:17472
  v_mfma_f32_16x16x32_bf16 v[44:47], a[32:35], a[224:227], 0
  s_add_u32 s62, s62, 8192
  ds_read_b128 v[120:123], v5 offset:34112
  ds_read_b128 v[124:127], v5 offset:50752
  v_mfma_f32_16x16x32_bf16 v[164:167], v[128:131], v[100:103], v[164:167]
  ds_read_b128 a[228:231], v9 offset:9360
  v_fmac_f32 v23, v36, v76
  v_mfma_f32_16x16x32_bf16 v[168:171], v[128:131], v[104:107], v[168:171]
  v_fmac_f32 v23, v37, v77
  v_fmac_f32 v23, v38, v78
  v_fmac_f32 v23, v39, v79
  v_mfma_f32_16x16x32_bf16 v[36:39], a[96:99], a[224:227], 0
  v_fmac_f32 v23, v43, v91
  v_fmac_f32 v24, v44, v64
  v_mfma_f32_16x16x32_bf16 v[172:175], v[128:131], v[108:111], v[172:175]
  s_waitcnt vmcnt(9)
  buffer_load_dwordx4 v[128:131], v4, s[32:35], s43 offen offset:0 sc1
  v_fmac_f32 v24, v45, v65
  v_fmac_f32 v24, v46, v66
  v_mfma_f32_16x16x32_bf16 v[188:191], v[132:135], v[108:111], v[188:191]
  v_fmac_f32 v24, v47, v67
  v_fmac_f32 v24, v36, v68
  v_mfma_f32_16x16x32_bf16 v[40:43], a[160:163], a[224:227], 0
  v_fmac_f32 v24, v37, v69
  v_fmac_f32 v24, v38, v70
  v_mfma_f32_16x16x32_bf16 v[184:187], v[132:135], v[104:107], v[184:187]
  v_fmac_f32 v24, v39, v71
  v_mfma_f32_16x16x32_bf16 v[44:47], a[224:227], a[224:227], 0
  v_mfma_f32_16x16x32_bf16 v[180:183], v[132:135], v[100:103], v[180:183]
  v_mfma_f32_16x16x32_bf16 v[176:179], v[132:135], v[96:99], v[176:179]
  buffer_load_dwordx4 v[132:135], v4, s[32:35], s43 offen offset:1024 sc1
  v_fmac_f32 v24, v40, v72
  v_fmac_f32 v24, v41, v73
  v_mfma_f32_16x16x32_bf16 v[36:39], v[56:59], a[224:227], 0
  s_waitcnt vmcnt(10) lgkmcnt(3)
  v_fmac_f32 v24, v42, v74
  v_fmac_f32 v24, v43, v75
  v_mfma_f32_16x16x32_bf16 v[160:163], v[136:139], v[112:115], v[160:163]
  s_waitcnt lgkmcnt(0)
  ds_read_b128 v[96:99], v5 offset:896
  ds_read_b128 v[100:103], v5 offset:17536
  v_mfma_f32_16x16x32_bf16 v[40:43], a[36:39], a[228:231], 0
  ds_read_b128 v[104:107], v5 offset:34176
  ds_read_b128 v[108:111], v5 offset:50816
  v_mfma_f32_16x16x32_bf16 v[164:167], v[136:139], v[116:119], v[164:167]
  ds_read_b128 a[232:235], v9 offset:10400
  v_fmac_f32 v24, v44, v76
  v_mfma_f32_16x16x32_bf16 v[168:171], v[136:139], v[120:123], v[168:171]
  v_fmac_f32 v24, v45, v77
  v_fmac_f32 v24, v46, v78
  v_fmac_f32 v24, v47, v79
  v_mfma_f32_16x16x32_bf16 v[44:47], a[100:103], a[228:231], 0
  v_fmac_f32 v24, v36, v91
  v_fmac_f32 v25, v40, v64
  v_mfma_f32_16x16x32_bf16 v[172:175], v[136:139], v[124:127], v[172:175]
  s_waitcnt vmcnt(8)
  buffer_load_dwordx4 v[136:139], v4, s[32:35], s43 offen offset:2048 sc1
  v_fmac_f32 v25, v41, v65
  v_fmac_f32 v25, v42, v66
  v_mfma_f32_16x16x32_bf16 v[188:191], v[140:143], v[124:127], v[188:191]
  v_fmac_f32 v25, v43, v67
  v_fmac_f32 v25, v44, v68
  v_mfma_f32_16x16x32_bf16 v[36:39], a[164:167], a[228:231], 0
  v_fmac_f32 v25, v45, v69
  v_fmac_f32 v25, v46, v70
  v_mfma_f32_16x16x32_bf16 v[184:187], v[140:143], v[120:123], v[184:187]
  v_fmac_f32 v25, v47, v71
  v_mfma_f32_16x16x32_bf16 v[40:43], a[228:231], a[228:231], 0
  v_mfma_f32_16x16x32_bf16 v[180:183], v[140:143], v[116:119], v[180:183]
  v_mfma_f32_16x16x32_bf16 v[176:179], v[140:143], v[112:115], v[176:179]
  buffer_load_dwordx4 v[140:143], v4, s[32:35], s43 offen offset:3072 sc1
  v_fmac_f32 v25, v36, v72
  v_fmac_f32 v25, v37, v73
  v_mfma_f32_16x16x32_bf16 v[44:47], v[56:59], a[228:231], 0
  s_waitcnt vmcnt(8) lgkmcnt(3)
  v_fmac_f32 v25, v38, v74
  v_fmac_f32 v25, v39, v75
  v_mfma_f32_16x16x32_bf16 v[160:163], v[144:147], v[96:99], v[160:163]
  s_waitcnt lgkmcnt(0)
  ds_read_b128 v[112:115], v5 offset:960
  ds_read_b128 v[116:119], v5 offset:17600
  v_mfma_f32_16x16x32_bf16 v[36:39], a[40:43], a[232:235], 0
  s_add_u32 s43, s43, 8192
  ds_read_b128 v[120:123], v5 offset:34240
  ds_read_b128 v[124:127], v5 offset:50880
  v_mfma_f32_16x16x32_bf16 v[164:167], v[144:147], v[100:103], v[164:167]
  ds_read_b128 a[236:239], v9 offset:11440
  v_fmac_f32 v25, v40, v76
  v_mfma_f32_16x16x32_bf16 v[168:171], v[144:147], v[104:107], v[168:171]
  v_fmac_f32 v25, v41, v77
  v_fmac_f32 v25, v42, v78
  v_fmac_f32 v25, v43, v79
  v_mfma_f32_16x16x32_bf16 v[40:43], a[104:107], a[232:235], 0
  v_fmac_f32 v25, v45, v91
  v_fmac_f32 v26, v36, v64
  v_mfma_f32_16x16x32_bf16 v[172:175], v[144:147], v[108:111], v[172:175]
  s_waitcnt vmcnt(7)
  buffer_load_dwordx4 v[144:147], v4, s[32:35], s62 offen offset:0 sc1
  v_fmac_f32 v26, v37, v65
  v_fmac_f32 v26, v38, v66
  v_mfma_f32_16x16x32_bf16 v[188:191], v[148:151], v[108:111], v[188:191]
  v_add_u32 v11, 66560, v11
  v_xad_u32 v5, v7, 0, v11
  v_mfma_f32_16x16x32_bf16 v[44:47], a[168:171], a[232:235], 0
  v_fmac_f32 v26, v39, v67
  v_fmac_f32 v26, v40, v68
  v_mfma_f32_16x16x32_bf16 v[184:187], v[148:151], v[104:107], v[184:187]
  v_fmac_f32 v26, v41, v69
  v_fmac_f32 v26, v42, v70
  v_mfma_f32_16x16x32_bf16 v[36:39], a[232:235], a[232:235], 0
  v_fmac_f32 v26, v43, v71
  v_mfma_f32_16x16x32_bf16 v[180:183], v[148:151], v[100:103], v[180:183]
  v_fmac_f32 v26, v44, v72
  v_fmac_f32 v26, v45, v73
  v_mfma_f32_16x16x32_bf16 v[176:179], v[148:151], v[96:99], v[176:179]
  buffer_load_dwordx4 v[148:151], v4, s[32:35], s62 offen offset:1024 sc1
  v_fmac_f32 v26, v46, v74
  v_fmac_f32 v26, v47, v75
  v_mfma_f32_16x16x32_bf16 v[40:43], v[56:59], a[232:235], 0
  s_waitcnt vmcnt(7) lgkmcnt(1)
  s_barrier
  v_fmac_f32 v26, v36, v76
  v_fmac_f32 v26, v37, v77
  v_mfma_f32_16x16x32_bf16 v[160:163], v[152:155], v[112:115], v[160:163]
  s_waitcnt lgkmcnt(0)
  ds_read_b128 v[96:99], v5 offset:0
  ds_read_b128 v[100:103], v5 offset:16640
  v_mfma_f32_16x16x32_bf16 v[44:47], a[44:47], a[236:239], 0
  s_add_u32 m0, s44, 0
  ds_read_b128 v[104:107], v5 offset:33280
  ds_read_b128 v[108:111], v5 offset:49920
  v_mfma_f32_16x16x32_bf16 v[164:167], v[152:155], v[116:119], v[164:167]
  v_xor_b32 v9, 16, v9
  ds_read_b128 a[240:243], v9 offset:12480
  v_add_u32_dpp v2, v252, v1 quad_perm:[0,0,0,0] row_mask:0xf bank_mask:0xf
  v_mfma_f32_16x16x32_bf16 v[168:171], v[152:155], v[120:123], v[168:171]
  buffer_load_dwordx4 v2, s[28:31], 0 offen lds
  v_fmac_f32 v26, v38, v78
  v_fmac_f32 v26, v39, v79
  v_mfma_f32_16x16x32_bf16 v[36:39], a[108:111], a[236:239], 0
  v_fmac_f32 v26, v42, v91
  v_fmac_f32 v27, v44, v64
  v_mfma_f32_16x16x32_bf16 v[172:175], v[152:155], v[124:127], v[172:175]
  s_waitcnt vmcnt(7)
  buffer_load_dwordx4 v[152:155], v4, s[32:35], s62 offen offset:2048 sc1
  v_fmac_f32 v27, v45, v65
  v_fmac_f32 v27, v46, v66
  v_mfma_f32_16x16x32_bf16 v[188:191], v[156:159], v[124:127], v[188:191]
  v_fmac_f32 v27, v47, v67
  v_fmac_f32 v27, v36, v68
  v_mfma_f32_16x16x32_bf16 v[40:43], a[172:175], a[236:239], 0
  v_fmac_f32 v27, v37, v69
  v_fmac_f32 v27, v38, v70
  v_mfma_f32_16x16x32_bf16 v[184:187], v[156:159], v[120:123], v[184:187]
  v_fmac_f32 v27, v39, v71
  v_mfma_f32_16x16x32_bf16 v[44:47], a[236:239], a[236:239], 0
  v_mfma_f32_16x16x32_bf16 v[180:183], v[156:159], v[116:119], v[180:183]
  v_mfma_f32_16x16x32_bf16 v[176:179], v[156:159], v[112:115], v[176:179]
  s_add_u32 m0, s44, 1040
  buffer_load_dwordx4 v[156:159], v4, s[32:35], s62 offen offset:3072 sc1
  v_add_u32_dpp v3, v252, v1 quad_perm:[1,1,1,1] row_mask:0xf bank_mask:0xf
  v_fmac_f32 v27, v40, v72
  v_mfma_f32_16x16x32_bf16 v[36:39], v[56:59], a[236:239], 0
  s_waitcnt vmcnt(8) lgkmcnt(3)
  buffer_load_dwordx4 v3, s[28:31], 0 offen lds
  v_fmac_f32 v27, v41, v73
  v_mfma_f32_16x16x32_bf16 v[160:163], v[128:131], v[96:99], v[160:163]
  s_waitcnt lgkmcnt(0)
  ds_read_b128 v[112:115], v5 offset:64
  ds_read_b128 v[116:119], v5 offset:16704
  v_fmac_f32 v27, v42, v74
  v_fmac_f32 v27, v43, v75
  v_mfma_f32_16x16x32_bf16 v[40:43], a[48:51], a[240:243], 0
  s_add_u32 s62, s62, 8192
  ds_read_b128 v[120:123], v5 offset:33344
  ds_read_b128 v[124:127], v5 offset:49984
  v_mfma_f32_16x16x32_bf16 v[164:167], v[128:131], v[100:103], v[164:167]
  ds_read_b128 a[244:247], v9 offset:13520
  v_fmac_f32 v27, v44, v76
  v_mfma_f32_16x16x32_bf16 v[168:171], v[128:131], v[104:107], v[168:171]
  v_fmac_f32 v27, v45, v77
  v_fmac_f32 v27, v46, v78
  v_fmac_f32 v27, v47, v79
  v_mfma_f32_16x16x32_bf16 v[44:47], a[112:115], a[240:243], 0
  v_fmac_f32 v27, v39, v91
  v_fmac_f32 v28, v40, v64
  v_mfma_f32_16x16x32_bf16 v[172:175], v[128:131], v[108:111], v[172:175]
  s_waitcnt vmcnt(8)
  buffer_load_dwordx4 v[128:131], v4, s[32:35], s43 offen offset:0 sc1
  v_fmac_f32 v28, v41, v65
  v_fmac_f32 v28, v42, v66
  v_mfma_f32_16x16x32_bf16 v[188:191], v[132:135], v[108:111], v[188:191]
  v_fmac_f32 v28, v43, v67
  v_fmac_f32 v28, v44, v68
  v_mfma_f32_16x16x32_bf16 v[36:39], a[176:179], a[240:243], 0
  v_fmac_f32 v28, v45, v69
  v_fmac_f32 v28, v46, v70
  v_mfma_f32_16x16x32_bf16 v[184:187], v[132:135], v[104:107], v[184:187]
  s_add_u32 m0, s44, 2080
  v_add_u32_dpp v2, v252, v1 quad_perm:[2,2,2,2] row_mask:0xf bank_mask:0xf
  v_fmac_f32 v28, v47, v71
  v_mfma_f32_16x16x32_bf16 v[40:43], a[240:243], a[240:243], 0
  buffer_load_dwordx4 v2, s[28:31], 0 offen lds
  v_fmac_f32 v28, v36, v72
  v_mfma_f32_16x16x32_bf16 v[180:183], v[132:135], v[100:103], v[180:183]
  v_fmac_f32 v28, v37, v73
  v_fmac_f32 v28, v38, v74
  v_mfma_f32_16x16x32_bf16 v[176:179], v[132:135], v[96:99], v[176:179]
  buffer_load_dwordx4 v[132:135], v4, s[32:35], s43 offen offset:1024 sc1
  v_fmac_f32 v28, v39, v75
  v_fmac_f32 v28, v40, v76
  v_mfma_f32_16x16x32_bf16 v[44:47], v[60:63], a[240:243], 0
  s_waitcnt vmcnt(10) lgkmcnt(3)
  v_fmac_f32 v28, v41, v77
  v_fmac_f32 v28, v42, v78
  v_mfma_f32_16x16x32_bf16 v[160:163], v[136:139], v[112:115], v[160:163]
  s_waitcnt lgkmcnt(0)
  ds_read_b128 v[96:99], v5 offset:128
  ds_read_b128 v[100:103], v5 offset:16768
  v_mfma_f32_16x16x32_bf16 v[36:39], a[52:55], a[244:247], 0
  ds_read_b128 v[104:107], v5 offset:33408
  ds_read_b128 v[108:111], v5 offset:50048
  v_mfma_f32_16x16x32_bf16 v[164:167], v[136:139], v[116:119], v[164:167]
  ds_read_b128 a[248:251], v9 offset:14560
  v_fmac_f32 v28, v43, v79
  v_mfma_f32_16x16x32_bf16 v[168:171], v[136:139], v[120:123], v[168:171]
  v_fmac_f32 v28, v44, v91
  v_mfma_f32_16x16x32_bf16 v[40:43], a[116:119], a[244:247], 0
  v_fmac_f32 v29, v36, v64
  v_fmac_f32 v29, v37, v65
  v_mfma_f32_16x16x32_bf16 v[172:175], v[136:139], v[124:127], v[172:175]
  s_waitcnt vmcnt(9)
  buffer_load_dwordx4 v[136:139], v4, s[32:35], s43 offen offset:2048 sc1
  v_fmac_f32 v29, v38, v66
  v_fmac_f32 v29, v39, v67
  v_mfma_f32_16x16x32_bf16 v[188:191], v[140:143], v[124:127], v[188:191]
  s_add_u32 m0, s44, 3120
  v_add_u32_dpp v3, v252, v1 quad_perm:[3,3,3,3] row_mask:0xf bank_mask:0xf
  v_fmac_f32 v29, v40, v68
  v_mfma_f32_16x16x32_bf16 v[44:47], a[180:183], a[244:247], 0
  buffer_load_dwordx4 v3, s[28:31], 0 offen lds
  v_fmac_f32 v29, v41, v69
  v_mfma_f32_16x16x32_bf16 v[184:187], v[140:143], v[120:123], v[184:187]
  v_fmac_f32 v29, v42, v70
  v_fmac_f32 v29, v43, v71
  v_mfma_f32_16x16x32_bf16 v[36:39], a[244:247], a[244:247], 0
  v_mfma_f32_16x16x32_bf16 v[180:183], v[140:143], v[116:119], v[180:183]
  v_mfma_f32_16x16x32_bf16 v[176:179], v[140:143], v[112:115], v[176:179]
  buffer_load_dwordx4 v[140:143], v4, s[32:35], s43 offen offset:3072 sc1
  v_fmac_f32 v29, v44, v72
  v_fmac_f32 v29, v45, v73
  v_mfma_f32_16x16x32_bf16 v[40:43], v[60:63], a[244:247], 0
  s_waitcnt vmcnt(11) lgkmcnt(3)
  v_fmac_f32 v29, v46, v74
  v_fmac_f32 v29, v47, v75
  v_mfma_f32_16x16x32_bf16 v[160:163], v[144:147], v[96:99], v[160:163]
  s_waitcnt lgkmcnt(0)
  ds_read_b128 v[112:115], v5 offset:192
  ds_read_b128 v[116:119], v5 offset:16832
  v_mfma_f32_16x16x32_bf16 v[44:47], a[56:59], a[248:251], 0
  s_add_u32 s43, s43, 8192
  ds_read_b128 v[120:123], v5 offset:33472
  ds_read_b128 v[124:127], v5 offset:50112
  v_mfma_f32_16x16x32_bf16 v[164:167], v[144:147], v[100:103], v[164:167]
  ds_read_b128 a[252:255], v9 offset:15600
  v_fmac_f32 v29, v36, v76
  v_mfma_f32_16x16x32_bf16 v[168:171], v[144:147], v[104:107], v[168:171]
  s_add_u32 m0, s44, 4160
  v_add_u32_dpp v2, v253, v6 quad_perm:[0,0,0,0] row_mask:0xf bank_mask:0xf
  v_fmac_f32 v29, v37, v77
  v_fmac_f32 v29, v38, v78
  v_fmac_f32 v29, v39, v79
  v_mfma_f32_16x16x32_bf16 v[36:39], a[120:123], a[248:251], 0
  buffer_load_dwordx4 v2, s[28:31], 0 offen lds
  v_fmac_f32 v29, v41, v91
  v_mfma_f32_16x16x32_bf16 v[172:175], v[144:147], v[108:111], v[172:175]
  s_waitcnt vmcnt(11)
  buffer_load_dwordx4 v[144:147], v4, s[32:35], s62 offen offset:0 sc1
  v_fmac_f32 v30, v44, v64
  v_fmac_f32 v30, v45, v65
  v_mfma_f32_16x16x32_bf16 v[188:191], v[148:151], v[108:111], v[188:191]
  v_xad_u32 v5, v7, 48, v11
  v_fmac_f32 v30, v46, v66
  v_mfma_f32_16x16x32_bf16 v[40:43], a[184:187], a[248:251], 0
  v_fmac_f32 v30, v47, v67
  v_fmac_f32 v30, v36, v68
  v_mfma_f32_16x16x32_bf16 v[184:187], v[148:151], v[104:107], v[184:187]
  v_fmac_f32 v30, v37, v69
  v_fmac_f32 v30, v38, v70
  v_mfma_f32_16x16x32_bf16 v[44:47], a[248:251], a[248:251], 0
  v_fmac_f32 v30, v39, v71
  v_mfma_f32_16x16x32_bf16 v[180:183], v[148:151], v[100:103], v[180:183]
  v_fmac_f32 v30, v40, v72
  v_fmac_f32 v30, v41, v73
  v_mfma_f32_16x16x32_bf16 v[176:179], v[148:151], v[96:99], v[176:179]
  buffer_load_dwordx4 v[148:151], v4, s[32:35], s62 offen offset:1024 sc1
  v_fmac_f32 v30, v42, v74
  v_fmac_f32 v30, v43, v75
  v_mfma_f32_16x16x32_bf16 v[36:39], v[60:63], a[248:251], 0
  s_waitcnt vmcnt(11) lgkmcnt(3)
  v_fmac_f32 v30, v44, v76
  v_fmac_f32 v30, v45, v77
  v_mfma_f32_16x16x32_bf16 v[160:163], v[152:155], v[112:115], v[160:163]
  s_waitcnt lgkmcnt(0)
  ds_read_b128 v[96:99], v5 offset:256
  ds_read_b128 v[100:103], v5 offset:16896
  v_mfma_f32_16x16x32_bf16 v[40:43], a[60:63], a[252:255], 0
  s_add_u32 m0, s44, 5200
  ds_read_b128 v[104:107], v5 offset:33536
  ds_read_b128 v[108:111], v5 offset:50176
  v_mfma_f32_16x16x32_bf16 v[164:167], v[152:155], v[116:119], v[164:167]
  ds_read_b128 v[192:195], v8 offset:0
  v_add_u32_dpp v3, v253, v6 quad_perm:[1,1,1,1] row_mask:0xf bank_mask:0xf
  v_mfma_f32_16x16x32_bf16 v[168:171], v[152:155], v[120:123], v[168:171]
  buffer_load_dwordx4 v3, s[28:31], 0 offen lds
  v_fmac_f32 v30, v46, v78
  v_fmac_f32 v30, v47, v79
  v_mfma_f32_16x16x32_bf16 v[44:47], a[124:127], a[252:255], 0
  v_fmac_f32 v30, v38, v91
  v_fmac_f32 v31, v40, v64
  v_mfma_f32_16x16x32_bf16 v[172:175], v[152:155], v[124:127], v[172:175]
  s_waitcnt vmcnt(11)
  buffer_load_dwordx4 v[152:155], v4, s[32:35], s62 offen offset:2048 sc1
  v_fmac_f32 v31, v41, v65
  v_fmac_f32 v31, v42, v66
  v_mfma_f32_16x16x32_bf16 v[188:191], v[156:159], v[124:127], v[188:191]
  v_fmac_f32 v31, v43, v67
  v_fmac_f32 v31, v44, v68
  v_mfma_f32_16x16x32_bf16 v[36:39], a[188:191], a[252:255], 0
  ds_read_b128 v[64:67], v10 offset:15360
  v_fmac_f32 v31, v45, v69
  v_mfma_f32_16x16x32_bf16 v[184:187], v[156:159], v[120:123], v[184:187]
  v_fmac_f32 v31, v46, v70
  v_fmac_f32 v31, v47, v71
  v_mfma_f32_16x16x32_bf16 v[40:43], a[252:255], a[252:255], 0
  ds_read_b128 v[68:71], v10 offset:16384
  v_mfma_f32_16x16x32_bf16 v[180:183], v[156:159], v[116:119], v[180:183]
  v_fmac_f32 v31, v36, v72
  v_fmac_f32 v31, v37, v73
  v_mfma_f32_16x16x32_bf16 v[176:179], v[156:159], v[112:115], v[176:179]
  s_add_u32 m0, s44, 6240
  buffer_load_dwordx4 v[156:159], v4, s[32:35], s62 offen offset:3072 sc1
  v_add_u32_dpp v2, v253, v6 quad_perm:[2,2,2,2] row_mask:0xf bank_mask:0xf
  v_fmac_f32 v31, v38, v74
  v_mfma_f32_16x16x32_bf16 v[44:47], v[60:63], a[252:255], 0
  s_waitcnt vmcnt(11) lgkmcnt(5)
  buffer_load_dwordx4 v2, s[28:31], 0 offen lds
  v_fmac_f32 v31, v39, v75
  v_mfma_f32_16x16x32_bf16 v[160:163], v[128:131], v[96:99], v[160:163]
  s_waitcnt lgkmcnt(2)
  ds_read_b128 v[72:75], v10 offset:17408
  ds_read_b128 v[112:115], v5 offset:320
  v_mfma_f32_16x16x32_bf16 v[36:39], a[0:3], v[192:195], 0
  s_add_u32 s62, s62, 8192
  ds_read_b128 v[116:119], v5 offset:16960
  ds_read_b128 v[120:123], v5 offset:33600
  v_mfma_f32_16x16x32_bf16 v[164:167], v[128:131], v[100:103], v[164:167]
  ds_read_b128 v[124:127], v5 offset:50240
  ds_read_b128 v[196:199], v8 offset:1040
  v_mfma_f32_16x16x32_bf16 v[168:171], v[128:131], v[104:107], v[168:171]
  v_fmac_f32 v31, v40, v76
  v_fmac_f32 v31, v41, v77
  v_fmac_f32 v31, v42, v78
  v_fmac_f32 v31, v43, v79
  v_mfma_f32_16x16x32_bf16 v[40:43], a[64:67], v[192:195], 0
  ds_read_b128 v[76:79], v10 offset:18432
  v_fmac_f32 v31, v47, v91
  v_mfma_f32_16x16x32_bf16 v[172:175], v[128:131], v[108:111], v[172:175]
  buffer_load_dwordx4 v[128:131], v4, s[32:35], s43 offen offset:0 sc1
  v_fmac_f32 v16, v36, v80
  v_fmac_f32 v16, v37, v81
  v_mfma_f32_16x16x32_bf16 v[44:47], a[128:131], v[192:195], 0
  s_waitcnt vmcnt(11)
  v_fmac_f32 v16, v38, v82
  v_fmac_f32 v16, v39, v83
  v_mfma_f32_16x16x32_bf16 v[188:191], v[132:135], v[108:111], v[188:191]
  v_fmac_f32 v16, v40, v84
  v_fmac_f32 v16, v41, v85
  v_mfma_f32_16x16x32_bf16 v[36:39], a[192:195], v[192:195], 0
  v_fmac_f32 v16, v42, v86
  v_fmac_f32 v16, v43, v87
  v_mfma_f32_16x16x32_bf16 v[184:187], v[132:135], v[104:107], v[184:187]
  s_add_u32 m0, s44, 7280
  v_add_u32_dpp v3, v253, v6 quad_perm:[3,3,3,3] row_mask:0xf bank_mask:0xf
  s_waitcnt lgkmcnt(8)
  v_fmac_f32 v16, v44, v64
  v_mfma_f32_16x16x32_bf16 v[180:183], v[132:135], v[100:103], v[180:183]
  buffer_load_dwordx4 v3, s[28:31], 0 offen lds
  v_fmac_f32 v16, v45, v65
  v_mfma_f32_16x16x32_bf16 v[40:43], v[192:195], v[192:195], 0
  v_fmac_f32 v16, v46, v66
  v_fmac_f32 v16, v47, v67
  v_mfma_f32_16x16x32_bf16 v[176:179], v[132:135], v[96:99], v[176:179]
  buffer_load_dwordx4 v[132:135], v4, s[32:35], s43 offen offset:1024 sc1
  s_waitcnt lgkmcnt(7)
  v_fmac_f32 v16, v36, v68
  v_fmac_f32 v16, v37, v69
  v_mfma_f32_16x16x32_bf16 v[44:47], v[48:51], v[192:195], 0
  s_waitcnt vmcnt(12) lgkmcnt(4)
  v_fmac_f32 v16, v38, v70
  v_fmac_f32 v16, v39, v71
  v_mfma_f32_16x16x32_bf16 v[160:163], v[136:139], v[112:115], v[160:163]
  s_waitcnt lgkmcnt(1)
  ds_read_b128 v[96:99], v5 offset:384
  ds_read_b128 v[100:103], v5 offset:17024
  v_mfma_f32_16x16x32_bf16 v[36:39], a[4:7], v[196:199], 0
  ds_read_b128 v[104:107], v5 offset:33664
  ds_read_b128 v[108:111], v5 offset:50304
  v_mfma_f32_16x16x32_bf16 v[164:167], v[136:139], v[116:119], v[164:167]
  ds_read_b128 v[200:203], v8 offset:2080
  v_fmac_f32 v16, v40, v72
  v_mfma_f32_16x16x32_bf16 v[168:171], v[136:139], v[120:123], v[168:171]
  v_fmac_f32 v16, v41, v73
  v_fmac_f32 v16, v42, v74
  v_fmac_f32 v16, v43, v75
  v_mfma_f32_16x16x32_bf16 v[40:43], a[68:71], v[196:199], 0
  v_fmac_f32 v16, v44, v88
  v_fmac_f32 v17, v36, v80
  v_mfma_f32_16x16x32_bf16 v[172:175], v[136:139], v[124:127], v[172:175]
  buffer_load_dwordx4 v[136:139], v4, s[32:35], s43 offen offset:2048 sc1
  v_fmac_f32 v17, v37, v81
  v_fmac_f32 v17, v38, v82
  v_mfma_f32_16x16x32_bf16 v[44:47], a[132:135], v[196:199], 0
  s_waitcnt vmcnt(11)
  v_add_u32_dpp v2, v254, v6 quad_perm:[0,0,0,0] row_mask:0xf bank_mask:0xf
  v_fmac_f32 v17, v39, v83
  v_mfma_f32_16x16x32_bf16 v[188:191], v[140:143], v[124:127], v[188:191]
  s_add_u32 m0, s44, 8320
  v_fmac_f32 v17, v40, v84
  v_fmac_f32 v17, v41, v85
  v_mfma_f32_16x16x32_bf16 v[36:39], a[196:199], v[196:199], 0
  buffer_load_dwordx4 v2, s[28:31], 0 offen lds
  v_fmac_f32 v17, v42, v86
  v_mfma_f32_16x16x32_bf16 v[184:187], v[140:143], v[120:123], v[184:187]
  v_fmac_f32 v17, v43, v87
  v_fmac_f32 v17, v44, v64
  v_mfma_f32_16x16x32_bf16 v[180:183], v[140:143], v[116:119], v[180:183]
  v_fmac_f32 v17, v45, v65
  v_fmac_f32 v17, v46, v66
  v_mfma_f32_16x16x32_bf16 v[40:43], v[196:199], v[196:199], 0
  v_fmac_f32 v17, v47, v67
  v_fmac_f32 v17, v36, v68
  v_mfma_f32_16x16x32_bf16 v[176:179], v[140:143], v[112:115], v[176:179]
  buffer_load_dwordx4 v[140:143], v4, s[32:35], s43 offen offset:3072 sc1
  v_fmac_f32 v17, v37, v69
  v_fmac_f32 v17, v38, v70
  v_mfma_f32_16x16x32_bf16 v[44:47], v[48:51], v[196:199], 0
  s_waitcnt vmcnt(11) lgkmcnt(3)
  v_fmac_f32 v17, v39, v71
  v_fmac_f32 v17, v40, v72
  v_mfma_f32_16x16x32_bf16 v[160:163], v[144:147], v[96:99], v[160:163]
  s_waitcnt lgkmcnt(0)
  ds_read_b128 v[112:115], v5 offset:448
  ds_read_b128 v[116:119], v5 offset:17088
  v_mfma_f32_16x16x32_bf16 v[36:39], a[8:11], v[200:203], 0
  s_add_u32 s43, s43, 8192
  ds_read_b128 v[120:123], v5 offset:33728
  ds_read_b128 v[124:127], v5 offset:50368
  v_mfma_f32_16x16x32_bf16 v[164:167], v[144:147], v[100:103], v[164:167]
  ds_read_b128 v[204:207], v8 offset:3120
  v_fmac_f32 v17, v41, v73
  v_mfma_f32_16x16x32_bf16 v[168:171], v[144:147], v[104:107], v[168:171]
  s_add_u32 m0, s44, 9360
  v_add_u32_dpp v3, v254, v6 quad_perm:[1,1,1,1] row_mask:0xf bank_mask:0xf
  v_fmac_f32 v17, v42, v74
  v_fmac_f32 v17, v43, v75
  v_mfma_f32_16x16x32_bf16 v[40:43], a[72:75], v[200:203], 0
  buffer_load_dwordx4 v3, s[28:31], 0 offen lds
  v_fmac_f32 v17, v45, v88
  v_mfma_f32_16x16x32_bf16 v[172:175], v[144:147], v[108:111], v[172:175]
  buffer_load_dwordx4 v[144:147], v4, s[32:35], s62 offen offset:0 sc1
  v_fmac_f32 v18, v36, v80
  v_fmac_f32 v18, v37, v81
  v_mfma_f32_16x16x32_bf16 v[44:47], a[136:139], v[200:203], 0
  s_waitcnt vmcnt(12)
  v_fmac_f32 v18, v38, v82
  v_fmac_f32 v18, v39, v83
  v_mfma_f32_16x16x32_bf16 v[188:191], v[148:151], v[108:111], v[188:191]
  v_xad_u32 v5, v7, 32, v11
  v_fmac_f32 v18, v40, v84
  v_mfma_f32_16x16x32_bf16 v[36:39], a[200:203], v[200:203], 0
  v_fmac_f32 v18, v41, v85
  v_fmac_f32 v18, v42, v86
  v_mfma_f32_16x16x32_bf16 v[184:187], v[148:151], v[104:107], v[184:187]
  v_fmac_f32 v18, v43, v87
  v_fmac_f32 v18, v44, v64
  v_mfma_f32_16x16x32_bf16 v[180:183], v[148:151], v[100:103], v[180:183]
  v_fmac_f32 v18, v45, v65
  v_fmac_f32 v18, v46, v66
  v_mfma_f32_16x16x32_bf16 v[40:43], v[200:203], v[200:203], 0
  v_fmac_f32 v18, v47, v67
  v_fmac_f32 v18, v36, v68
  v_mfma_f32_16x16x32_bf16 v[176:179], v[148:151], v[96:99], v[176:179]
  buffer_load_dwordx4 v[148:151], v4, s[32:35], s62 offen offset:1024 sc1
  v_fmac_f32 v18, v37, v69
  v_fmac_f32 v18, v38, v70
  v_mfma_f32_16x16x32_bf16 v[44:47], v[48:51], v[200:203], 0
  s_waitcnt vmcnt(11) lgkmcnt(3)
  v_fmac_f32 v18, v39, v71
  v_fmac_f32 v18, v40, v72
  v_mfma_f32_16x16x32_bf16 v[160:163], v[152:155], v[112:115], v[160:163]
  s_waitcnt lgkmcnt(0)
  ds_read_b128 v[96:99], v5 offset:512
  ds_read_b128 v[100:103], v5 offset:17152
  v_mfma_f32_16x16x32_bf16 v[36:39], a[12:15], v[204:207], 0
  s_add_u32 m0, s44, 10400
  ds_read_b128 v[104:107], v5 offset:33792
  ds_read_b128 v[108:111], v5 offset:50432
  v_mfma_f32_16x16x32_bf16 v[164:167], v[152:155], v[116:119], v[164:167]
  v_xor_b32 v8, 16, v8
  ds_read_b128 v[208:211], v8 offset:4160
  v_add_u32_dpp v2, v254, v6 quad_perm:[2,2,2,2] row_mask:0xf bank_mask:0xf
  v_mfma_f32_16x16x32_bf16 v[168:171], v[152:155], v[120:123], v[168:171]
  buffer_load_dwordx4 v2, s[28:31], 0 offen lds
  v_fmac_f32 v18, v41, v73
  v_fmac_f32 v18, v42, v74
  v_fmac_f32 v18, v43, v75
  v_mfma_f32_16x16x32_bf16 v[40:43], a[76:79], v[204:207], 0
  v_fmac_f32 v18, v46, v88
  v_fmac_f32 v19, v36, v80
  v_mfma_f32_16x16x32_bf16 v[172:175], v[152:155], v[124:127], v[172:175]
  buffer_load_dwordx4 v[152:155], v4, s[32:35], s62 offen offset:2048 sc1
  v_fmac_f32 v19, v37, v81
  v_fmac_f32 v19, v38, v82
  v_mfma_f32_16x16x32_bf16 v[44:47], a[140:143], v[204:207], 0
  s_waitcnt vmcnt(12)
  v_fmac_f32 v19, v39, v83
  v_fmac_f32 v19, v40, v84
  v_mfma_f32_16x16x32_bf16 v[188:191], v[156:159], v[124:127], v[188:191]
  v_fmac_f32 v19, v41, v85
  v_fmac_f32 v19, v42, v86
  v_mfma_f32_16x16x32_bf16 v[36:39], a[204:207], v[204:207], 0
  v_fmac_f32 v19, v43, v87
  v_fmac_f32 v19, v44, v64
  v_mfma_f32_16x16x32_bf16 v[184:187], v[156:159], v[120:123], v[184:187]
  v_fmac_f32 v19, v45, v65
  v_fmac_f32 v19, v46, v66
  v_mfma_f32_16x16x32_bf16 v[180:183], v[156:159], v[116:119], v[180:183]
  v_fmac_f32 v19, v47, v67
  v_mfma_f32_16x16x32_bf16 v[40:43], v[204:207], v[204:207], 0
  v_fmac_f32 v19, v36, v68
  v_fmac_f32 v19, v37, v69
  v_mfma_f32_16x16x32_bf16 v[176:179], v[156:159], v[112:115], v[176:179]
  s_add_u32 m0, s44, 11440
  buffer_load_dwordx4 v[156:159], v4, s[32:35], s62 offen offset:3072 sc1
  v_add_u32_dpp v3, v254, v6 quad_perm:[3,3,3,3] row_mask:0xf bank_mask:0xf
  v_fmac_f32 v19, v38, v70
  v_mfma_f32_16x16x32_bf16 v[44:47], v[48:51], v[204:207], 0
  s_waitcnt vmcnt(11) lgkmcnt(3)
  buffer_load_dwordx4 v3, s[28:31], 0 offen lds
  v_fmac_f32 v19, v39, v71
  v_mfma_f32_16x16x32_bf16 v[160:163], v[128:131], v[96:99], v[160:163]
  s_waitcnt lgkmcnt(0)
  ds_read_b128 v[112:115], v5 offset:576
  ds_read_b128 v[116:119], v5 offset:17216
  v_mfma_f32_16x16x32_bf16 v[36:39], a[16:19], v[208:211], 0
  s_add_u32 s62, s62, 8192
  ds_read_b128 v[120:123], v5 offset:33856
  ds_read_b128 v[124:127], v5 offset:50496
  v_mfma_f32_16x16x32_bf16 v[164:167], v[128:131], v[100:103], v[164:167]
  ds_read_b128 v[212:215], v8 offset:5200
  v_fmac_f32 v19, v40, v72
  v_mfma_f32_16x16x32_bf16 v[168:171], v[128:131], v[104:107], v[168:171]
  v_fmac_f32 v19, v41, v73
  v_fmac_f32 v19, v42, v74
  v_fmac_f32 v19, v43, v75
  v_mfma_f32_16x16x32_bf16 v[40:43], a[80:83], v[208:211], 0
  v_fmac_f32 v19, v47, v88
  v_fmac_f32 v20, v36, v80
  v_mfma_f32_16x16x32_bf16 v[172:175], v[128:131], v[108:111], v[172:175]
  buffer_load_dwordx4 v[128:131], v4, s[32:35], s43 offen offset:0 sc1
  v_fmac_f32 v20, v37, v81
  v_fmac_f32 v20, v38, v82
  v_mfma_f32_16x16x32_bf16 v[44:47], a[144:147], v[208:211], 0
  s_waitcnt vmcnt(11)
  v_fmac_f32 v20, v39, v83
  v_fmac_f32 v20, v40, v84
  v_mfma_f32_16x16x32_bf16 v[188:191], v[132:135], v[108:111], v[188:191]
  v_fmac_f32 v20, v41, v85
  v_fmac_f32 v20, v42, v86
  v_mfma_f32_16x16x32_bf16 v[36:39], a[208:211], v[208:211], 0
  v_fmac_f32 v20, v43, v87
  v_fmac_f32 v20, v44, v64
  v_mfma_f32_16x16x32_bf16 v[184:187], v[132:135], v[104:107], v[184:187]
  s_add_u32 m0, s44, 12480
  v_add_u32_dpp v2, v255, v1 quad_perm:[0,0,0,0] row_mask:0xf bank_mask:0xf
  v_fmac_f32 v20, v45, v65
  v_mfma_f32_16x16x32_bf16 v[180:183], v[132:135], v[100:103], v[180:183]
  buffer_load_dwordx4 v2, s[28:31], 0 offen lds
  v_fmac_f32 v20, v46, v66
  v_mfma_f32_16x16x32_bf16 v[40:43], v[208:211], v[208:211], 0
  v_fmac_f32 v20, v47, v67
  v_fmac_f32 v20, v36, v68
  v_mfma_f32_16x16x32_bf16 v[176:179], v[132:135], v[96:99], v[176:179]
  buffer_load_dwordx4 v[132:135], v4, s[32:35], s43 offen offset:1024 sc1
  v_fmac_f32 v20, v37, v69
  v_fmac_f32 v20, v38, v70
  v_mfma_f32_16x16x32_bf16 v[44:47], v[52:55], v[208:211], 0
  s_waitcnt vmcnt(12) lgkmcnt(3)
  v_fmac_f32 v20, v39, v71
  v_fmac_f32 v20, v40, v72
  v_mfma_f32_16x16x32_bf16 v[160:163], v[136:139], v[112:115], v[160:163]
  s_waitcnt lgkmcnt(0)
  ds_read_b128 v[96:99], v5 offset:640
  ds_read_b128 v[100:103], v5 offset:17280
  v_mfma_f32_16x16x32_bf16 v[36:39], a[20:23], v[212:215], 0
  ds_read_b128 v[104:107], v5 offset:33920
  ds_read_b128 v[108:111], v5 offset:50560
  v_mfma_f32_16x16x32_bf16 v[164:167], v[136:139], v[116:119], v[164:167]
  ds_read_b128 v[216:219], v8 offset:6240
  v_fmac_f32 v20, v41, v73
  v_mfma_f32_16x16x32_bf16 v[168:171], v[136:139], v[120:123], v[168:171]
  v_fmac_f32 v20, v42, v74
  v_fmac_f32 v20, v43, v75
  v_mfma_f32_16x16x32_bf16 v[40:43], a[84:87], v[212:215], 0
  v_fmac_f32 v20, v44, v88
  v_fmac_f32 v21, v36, v80
  v_mfma_f32_16x16x32_bf16 v[172:175], v[136:139], v[124:127], v[172:175]
  buffer_load_dwordx4 v[136:139], v4, s[32:35], s43 offen offset:2048 sc1
  v_fmac_f32 v21, v37, v81
  v_fmac_f32 v21, v38, v82
  v_mfma_f32_16x16x32_bf16 v[44:47], a[148:151], v[212:215], 0
  s_waitcnt vmcnt(11)
  v_add_u32_dpp v3, v255, v1 quad_perm:[1,1,1,1] row_mask:0xf bank_mask:0xf
  v_fmac_f32 v21, v39, v83
  v_mfma_f32_16x16x32_bf16 v[188:191], v[140:143], v[124:127], v[188:191]
  s_add_u32 m0, s44, 13520
  v_fmac_f32 v21, v40, v84
  v_fmac_f32 v21, v41, v85
  v_mfma_f32_16x16x32_bf16 v[36:39], a[212:215], v[212:215], 0
  buffer_load_dwordx4 v3, s[28:31], 0 offen lds
  v_fmac_f32 v21, v42, v86
  v_mfma_f32_16x16x32_bf16 v[184:187], v[140:143], v[120:123], v[184:187]
  v_fmac_f32 v21, v43, v87
  v_fmac_f32 v21, v44, v64
  v_mfma_f32_16x16x32_bf16 v[180:183], v[140:143], v[116:119], v[180:183]
  v_fmac_f32 v21, v45, v65
  v_fmac_f32 v21, v46, v66
  v_mfma_f32_16x16x32_bf16 v[40:43], v[212:215], v[212:215], 0
  v_fmac_f32 v21, v47, v67
  v_fmac_f32 v21, v36, v68
  v_mfma_f32_16x16x32_bf16 v[176:179], v[140:143], v[112:115], v[176:179]
  buffer_load_dwordx4 v[140:143], v4, s[32:35], s43 offen offset:3072 sc1
  v_fmac_f32 v21, v37, v69
  v_fmac_f32 v21, v38, v70
  v_mfma_f32_16x16x32_bf16 v[44:47], v[52:55], v[212:215], 0
  s_waitcnt vmcnt(11) lgkmcnt(3)
  v_fmac_f32 v21, v39, v71
  v_fmac_f32 v21, v40, v72
  v_mfma_f32_16x16x32_bf16 v[160:163], v[144:147], v[96:99], v[160:163]
  s_waitcnt lgkmcnt(0)
  ds_read_b128 v[112:115], v5 offset:704
  ds_read_b128 v[116:119], v5 offset:17344
  v_mfma_f32_16x16x32_bf16 v[36:39], a[24:27], v[216:219], 0
  s_add_u32 s43, s43, 8192
  ds_read_b128 v[120:123], v5 offset:33984
  ds_read_b128 v[124:127], v5 offset:50624
  v_mfma_f32_16x16x32_bf16 v[164:167], v[144:147], v[100:103], v[164:167]
  ds_read_b128 v[220:223], v8 offset:7280
  v_fmac_f32 v21, v41, v73
  v_mfma_f32_16x16x32_bf16 v[168:171], v[144:147], v[104:107], v[168:171]
  s_add_u32 m0, s44, 14560
  v_add_u32_dpp v2, v255, v1 quad_perm:[2,2,2,2] row_mask:0xf bank_mask:0xf
  v_fmac_f32 v21, v42, v74
  v_fmac_f32 v21, v43, v75
  v_mfma_f32_16x16x32_bf16 v[40:43], a[88:91], v[216:219], 0
  buffer_load_dwordx4 v2, s[28:31], 0 offen lds
  v_fmac_f32 v21, v45, v88
  v_mfma_f32_16x16x32_bf16 v[172:175], v[144:147], v[108:111], v[172:175]
  buffer_load_dwordx4 v[144:147], v4, s[32:35], s62 offen offset:0 sc1
  v_fmac_f32 v22, v36, v80
  v_fmac_f32 v22, v37, v81
  v_mfma_f32_16x16x32_bf16 v[44:47], a[152:155], v[216:219], 0
  s_waitcnt vmcnt(12)
  v_fmac_f32 v22, v38, v82
  v_fmac_f32 v22, v39, v83
  v_mfma_f32_16x16x32_bf16 v[188:191], v[148:151], v[108:111], v[188:191]
  v_xad_u32 v5, v7, 16, v11
  v_fmac_f32 v22, v40, v84
  v_mfma_f32_16x16x32_bf16 v[36:39], a[216:219], v[216:219], 0
  v_fmac_f32 v22, v41, v85
  v_fmac_f32 v22, v42, v86
  v_mfma_f32_16x16x32_bf16 v[184:187], v[148:151], v[104:107], v[184:187]
  v_fmac_f32 v22, v43, v87
  v_fmac_f32 v22, v44, v64
  v_mfma_f32_16x16x32_bf16 v[180:183], v[148:151], v[100:103], v[180:183]
  v_fmac_f32 v22, v45, v65
  v_fmac_f32 v22, v46, v66
  v_mfma_f32_16x16x32_bf16 v[40:43], v[216:219], v[216:219], 0
  v_fmac_f32 v22, v47, v67
  v_fmac_f32 v22, v36, v68
  v_mfma_f32_16x16x32_bf16 v[176:179], v[148:151], v[96:99], v[176:179]
  buffer_load_dwordx4 v[148:151], v4, s[32:35], s62 offen offset:1024 sc1
  v_fmac_f32 v22, v37, v69
  v_fmac_f32 v22, v38, v70
  v_mfma_f32_16x16x32_bf16 v[44:47], v[52:55], v[216:219], 0
  s_waitcnt vmcnt(11) lgkmcnt(3)
  v_fmac_f32 v22, v39, v71
  v_fmac_f32 v22, v40, v72
  v_mfma_f32_16x16x32_bf16 v[160:163], v[152:155], v[112:115], v[160:163]
  s_waitcnt lgkmcnt(0)
  ds_read_b128 v[96:99], v5 offset:768
  ds_read_b128 v[100:103], v5 offset:17408
  v_mfma_f32_16x16x32_bf16 v[36:39], a[28:31], v[220:223], 0
  s_add_u32 m0, s44, 15600
  ds_read_b128 v[104:107], v5 offset:34048
  ds_read_b128 v[108:111], v5 offset:50688
  v_mfma_f32_16x16x32_bf16 v[164:167], v[152:155], v[116:119], v[164:167]
  ds_read_b128 v[224:227], v8 offset:8320
  v_add_u32_dpp v3, v255, v1 quad_perm:[3,3,3,3] row_mask:0xf bank_mask:0xf
  v_mfma_f32_16x16x32_bf16 v[168:171], v[152:155], v[120:123], v[168:171]
  buffer_load_dwordx4 v3, s[28:31], 0 offen lds
  v_fmac_f32 v22, v41, v73
  v_fmac_f32 v22, v42, v74
  v_fmac_f32 v22, v43, v75
  v_mfma_f32_16x16x32_bf16 v[40:43], a[92:95], v[220:223], 0
  v_fmac_f32 v22, v46, v88
  v_fmac_f32 v23, v36, v80
  v_mfma_f32_16x16x32_bf16 v[172:175], v[152:155], v[124:127], v[172:175]
  buffer_load_dwordx4 v[152:155], v4, s[32:35], s62 offen offset:2048 sc1
  v_fmac_f32 v23, v37, v81
  v_fmac_f32 v23, v38, v82
  v_mfma_f32_16x16x32_bf16 v[44:47], a[156:159], v[220:223], 0
  s_waitcnt vmcnt(12)
  v_fmac_f32 v23, v39, v83
  v_fmac_f32 v23, v40, v84
  v_mfma_f32_16x16x32_bf16 v[188:191], v[156:159], v[124:127], v[188:191]
  v_fmac_f32 v23, v41, v85
  v_fmac_f32 v23, v42, v86
  v_mfma_f32_16x16x32_bf16 v[36:39], a[220:223], v[220:223], 0
  v_fmac_f32 v23, v43, v87
  v_fmac_f32 v23, v44, v64
  v_mfma_f32_16x16x32_bf16 v[184:187], v[156:159], v[120:123], v[184:187]
  v_fmac_f32 v23, v45, v65
  v_fmac_f32 v23, v46, v66
  v_mfma_f32_16x16x32_bf16 v[180:183], v[156:159], v[116:119], v[180:183]
  v_fmac_f32 v23, v47, v67
  v_mfma_f32_16x16x32_bf16 v[40:43], v[220:223], v[220:223], 0
  v_fmac_f32 v23, v36, v68
  v_fmac_f32 v23, v37, v69
  v_mfma_f32_16x16x32_bf16 v[176:179], v[156:159], v[112:115], v[176:179]
  buffer_load_dwordx4 v[156:159], v4, s[32:35], s62 offen offset:3072 sc1
  v_fmac_f32 v23, v38, v70
  v_fmac_f32 v23, v39, v71
  v_mfma_f32_16x16x32_bf16 v[44:47], v[52:55], v[220:223], 0
  s_waitcnt vmcnt(11) lgkmcnt(3)
  v_fmac_f32 v23, v40, v72
  v_fmac_f32 v23, v41, v73
  v_mfma_f32_16x16x32_bf16 v[160:163], v[128:131], v[96:99], v[160:163]
  s_waitcnt lgkmcnt(0)
  ds_read_b128 v[112:115], v5 offset:832
  ds_read_b128 v[116:119], v5 offset:17472
  v_mfma_f32_16x16x32_bf16 v[36:39], a[32:35], v[224:227], 0
  s_add_u32 s62, s62, 8192
  ds_read_b128 v[120:123], v5 offset:34112
  ds_read_b128 v[124:127], v5 offset:50752
  v_mfma_f32_16x16x32_bf16 v[164:167], v[128:131], v[100:103], v[164:167]
  ds_read_b128 v[228:231], v8 offset:9360
  v_fmac_f32 v23, v42, v74
  v_mfma_f32_16x16x32_bf16 v[168:171], v[128:131], v[104:107], v[168:171]
  v_fmac_f32 v23, v43, v75
  v_fmac_f32 v23, v47, v88
  v_mfma_f32_16x16x32_bf16 v[40:43], a[96:99], v[224:227], 0
  v_fmac_f32 v24, v36, v80
  v_fmac_f32 v24, v37, v81
  v_mfma_f32_16x16x32_bf16 v[172:175], v[128:131], v[108:111], v[172:175]
  buffer_load_dwordx4 v[128:131], v4, s[32:35], s43 offen offset:0 sc1
  v_fmac_f32 v24, v38, v82
  v_fmac_f32 v24, v39, v83
  v_mfma_f32_16x16x32_bf16 v[44:47], a[160:163], v[224:227], 0
  s_waitcnt vmcnt(10)
  v_fmac_f32 v24, v40, v84
  v_fmac_f32 v24, v41, v85
  v_mfma_f32_16x16x32_bf16 v[188:191], v[132:135], v[108:111], v[188:191]
  v_fmac_f32 v24, v42, v86
  v_fmac_f32 v24, v43, v87
  v_mfma_f32_16x16x32_bf16 v[36:39], a[224:227], v[224:227], 0
  v_mfma_f32_16x16x32_bf16 v[184:187], v[132:135], v[104:107], v[184:187]
  v_fmac_f32 v24, v44, v64
  v_fmac_f32 v24, v45, v65
  v_mfma_f32_16x16x32_bf16 v[180:183], v[132:135], v[100:103], v[180:183]
  v_fmac_f32 v24, v46, v66
  v_fmac_f32 v24, v47, v67
  v_mfma_f32_16x16x32_bf16 v[40:43], v[224:227], v[224:227], 0
  v_mfma_f32_16x16x32_bf16 v[176:179], v[132:135], v[96:99], v[176:179]
  buffer_load_dwordx4 v[132:135], v4, s[32:35], s43 offen offset:1024 sc1
  v_fmac_f32 v24, v36, v68
  v_fmac_f32 v24, v37, v69
  v_mfma_f32_16x16x32_bf16 v[44:47], v[56:59], v[224:227], 0
  s_waitcnt vmcnt(10) lgkmcnt(3)
  v_fmac_f32 v24, v38, v70
  v_fmac_f32 v24, v39, v71
  v_mfma_f32_16x16x32_bf16 v[160:163], v[136:139], v[112:115], v[160:163]
  s_waitcnt lgkmcnt(0)
  ds_read_b128 v[96:99], v5 offset:896
  ds_read_b128 v[100:103], v5 offset:17536
  v_mfma_f32_16x16x32_bf16 v[36:39], a[36:39], v[228:231], 0
  ds_read_b128 v[104:107], v5 offset:34176
  ds_read_b128 v[108:111], v5 offset:50816
  v_mfma_f32_16x16x32_bf16 v[164:167], v[136:139], v[116:119], v[164:167]
  ds_read_b128 v[232:235], v8 offset:10400
  v_fmac_f32 v24, v40, v72
  v_mfma_f32_16x16x32_bf16 v[168:171], v[136:139], v[120:123], v[168:171]
  v_fmac_f32 v24, v41, v73
  v_fmac_f32 v24, v42, v74
  v_fmac_f32 v24, v43, v75
  v_mfma_f32_16x16x32_bf16 v[40:43], a[100:103], v[228:231], 0
  v_fmac_f32 v24, v44, v88
  v_fmac_f32 v25, v36, v80
  v_mfma_f32_16x16x32_bf16 v[172:175], v[136:139], v[124:127], v[172:175]
  buffer_load_dwordx4 v[136:139], v4, s[32:35], s43 offen offset:2048 sc1
  v_fmac_f32 v25, v37, v81
  v_fmac_f32 v25, v38, v82
  v_mfma_f32_16x16x32_bf16 v[44:47], a[164:167], v[228:231], 0
  s_waitcnt vmcnt(9)
  v_fmac_f32 v25, v39, v83
  v_fmac_f32 v25, v40, v84
  v_mfma_f32_16x16x32_bf16 v[188:191], v[140:143], v[124:127], v[188:191]
  v_fmac_f32 v25, v41, v85
  v_fmac_f32 v25, v42, v86
  v_mfma_f32_16x16x32_bf16 v[36:39], a[228:231], v[228:231], 0
  v_fmac_f32 v25, v43, v87
  v_fmac_f32 v25, v44, v64
  v_mfma_f32_16x16x32_bf16 v[184:187], v[140:143], v[120:123], v[184:187]
  v_fmac_f32 v25, v45, v65
  v_fmac_f32 v25, v46, v66
  v_mfma_f32_16x16x32_bf16 v[180:183], v[140:143], v[116:119], v[180:183]
  v_fmac_f32 v25, v47, v67
  v_mfma_f32_16x16x32_bf16 v[40:43], v[228:231], v[228:231], 0
  v_fmac_f32 v25, v36, v68
  v_fmac_f32 v25, v37, v69
  v_mfma_f32_16x16x32_bf16 v[176:179], v[140:143], v[112:115], v[176:179]
  buffer_load_dwordx4 v[140:143], v4, s[32:35], s43 offen offset:3072 sc1
  v_fmac_f32 v25, v38, v70
  v_fmac_f32 v25, v39, v71
  v_mfma_f32_16x16x32_bf16 v[44:47], v[56:59], v[228:231], 0
  s_waitcnt vmcnt(8) lgkmcnt(3)
  v_fmac_f32 v25, v40, v72
  v_fmac_f32 v25, v41, v73
  v_mfma_f32_16x16x32_bf16 v[160:163], v[144:147], v[96:99], v[160:163]
  s_waitcnt lgkmcnt(0)
  ds_read_b128 v[112:115], v5 offset:960
  ds_read_b128 v[116:119], v5 offset:17600
  v_mfma_f32_16x16x32_bf16 v[36:39], a[40:43], v[232:235], 0
  s_add_u32 s43, s43, 8192
  ds_read_b128 v[120:123], v5 offset:34240
  ds_read_b128 v[124:127], v5 offset:50880
  v_mfma_f32_16x16x32_bf16 v[164:167], v[144:147], v[100:103], v[164:167]
  ds_read_b128 v[236:239], v8 offset:11440
  v_fmac_f32 v25, v42, v74
  v_mfma_f32_16x16x32_bf16 v[168:171], v[144:147], v[104:107], v[168:171]
  v_fmac_f32 v25, v43, v75
  v_fmac_f32 v25, v45, v88
  v_mfma_f32_16x16x32_bf16 v[40:43], a[104:107], v[232:235], 0
  v_fmac_f32 v26, v36, v80
  v_fmac_f32 v26, v37, v81
  v_mfma_f32_16x16x32_bf16 v[172:175], v[144:147], v[108:111], v[172:175]
  buffer_load_dwordx4 v[144:147], v4, s[32:35], s62 offen offset:0 sc1
  v_fmac_f32 v26, v38, v82
  v_fmac_f32 v26, v39, v83
  v_mfma_f32_16x16x32_bf16 v[44:47], a[168:171], v[232:235], 0
  s_waitcnt vmcnt(8)
  v_fmac_f32 v26, v40, v84
  v_fmac_f32 v26, v41, v85
  v_mfma_f32_16x16x32_bf16 v[188:191], v[148:151], v[108:111], v[188:191]
  v_subrev_u32 v11, 66560, v11
  v_xad_u32 v5, v7, 0, v11
  v_mfma_f32_16x16x32_bf16 v[36:39], a[232:235], v[232:235], 0
  v_fmac_f32 v26, v42, v86
  v_fmac_f32 v26, v43, v87
  v_mfma_f32_16x16x32_bf16 v[184:187], v[148:151], v[104:107], v[184:187]
  v_fmac_f32 v26, v44, v64
  v_fmac_f32 v26, v45, v65
  v_mfma_f32_16x16x32_bf16 v[180:183], v[148:151], v[100:103], v[180:183]
  v_fmac_f32 v26, v46, v66
  v_fmac_f32 v26, v47, v67
  v_mfma_f32_16x16x32_bf16 v[40:43], v[232:235], v[232:235], 0
  v_fmac_f32 v26, v36, v68
  v_fmac_f32 v26, v37, v69
  v_mfma_f32_16x16x32_bf16 v[176:179], v[148:151], v[96:99], v[176:179]
  buffer_load_dwordx4 v[148:151], v4, s[32:35], s62 offen offset:1024 sc1
  v_fmac_f32 v26, v38, v70
  v_fmac_f32 v26, v39, v71
  v_mfma_f32_16x16x32_bf16 v[44:47], v[56:59], v[232:235], 0
  s_waitcnt vmcnt(7) lgkmcnt(1)
  s_barrier
  v_fmac_f32 v26, v40, v72
  v_fmac_f32 v26, v41, v73
  v_mfma_f32_16x16x32_bf16 v[160:163], v[152:155], v[112:115], v[160:163]
  s_waitcnt lgkmcnt(0)
  ds_read_b128 v[96:99], v5 offset:0
  ds_read_b128 v[100:103], v5 offset:16640
  v_mfma_f32_16x16x32_bf16 v[36:39], a[44:47], v[236:239], 0
  s_add_u32 m0, s44, 66560
  ds_read_b128 v[104:107], v5 offset:33280
  ds_read_b128 v[108:111], v5 offset:49920
  v_mfma_f32_16x16x32_bf16 v[164:167], v[152:155], v[116:119], v[164:167]
  v_xor_b32 v8, 16, v8
  ds_read_b128 v[240:243], v8 offset:12480
  v_add_u32_dpp v2, v92, v1 quad_perm:[0,0,0,0] row_mask:0xf bank_mask:0xf
  v_mfma_f32_16x16x32_bf16 v[168:171], v[152:155], v[120:123], v[168:171]
  buffer_load_dwordx4 v2, s[28:31], 0 offen lds
  v_fmac_f32 v26, v42, v74
  v_fmac_f32 v26, v43, v75
  v_mfma_f32_16x16x32_bf16 v[40:43], a[108:111], v[236:239], 0
  v_fmac_f32 v26, v46, v88
  v_fmac_f32 v27, v36, v80
  v_mfma_f32_16x16x32_bf16 v[172:175], v[152:155], v[124:127], v[172:175]
  buffer_load_dwordx4 v[152:155], v4, s[32:35], s62 offen offset:2048 sc1
  v_fmac_f32 v27, v37, v81
  v_fmac_f32 v27, v38, v82
  v_mfma_f32_16x16x32_bf16 v[44:47], a[172:175], v[236:239], 0
  s_waitcnt vmcnt(8)
  v_fmac_f32 v27, v39, v83
  v_fmac_f32 v27, v40, v84
  v_mfma_f32_16x16x32_bf16 v[188:191], v[156:159], v[124:127], v[188:191]
  v_fmac_f32 v27, v41, v85
  v_fmac_f32 v27, v42, v86
  v_mfma_f32_16x16x32_bf16 v[36:39], a[236:239], v[236:239], 0
  v_fmac_f32 v27, v43, v87
  v_fmac_f32 v27, v44, v64
  v_mfma_f32_16x16x32_bf16 v[184:187], v[156:159], v[120:123], v[184:187]
  v_fmac_f32 v27, v45, v65
  v_fmac_f32 v27, v46, v66
  v_mfma_f32_16x16x32_bf16 v[180:183], v[156:159], v[116:119], v[180:183]
  s_add_u32 m0, s44, 67600
  v_add_u32_dpp v3, v92, v1 quad_perm:[1,1,1,1] row_mask:0xf bank_mask:0xf
  v_fmac_f32 v27, v47, v67
  v_mfma_f32_16x16x32_bf16 v[40:43], v[236:239], v[236:239], 0
  buffer_load_dwordx4 v3, s[28:31], 0 offen lds
  v_fmac_f32 v27, v36, v68
  v_mfma_f32_16x16x32_bf16 v[176:179], v[156:159], v[112:115], v[176:179]
  buffer_load_dwordx4 v[156:159], v4, s[32:35], s62 offen offset:3072 sc1
  v_fmac_f32 v27, v37, v69
  v_fmac_f32 v27, v38, v70
  v_mfma_f32_16x16x32_bf16 v[44:47], v[56:59], v[236:239], 0
  s_waitcnt vmcnt(9) lgkmcnt(3)
  v_fmac_f32 v27, v39, v71
  v_fmac_f32 v27, v40, v72
  v_mfma_f32_16x16x32_bf16 v[160:163], v[128:131], v[96:99], v[160:163]
  s_waitcnt lgkmcnt(0)
  ds_read_b128 v[112:115], v5 offset:64
  ds_read_b128 v[116:119], v5 offset:16704
  v_mfma_f32_16x16x32_bf16 v[36:39], a[48:51], v[240:243], 0
  s_add_u32 s62, s62, 8192
  ds_read_b128 v[120:123], v5 offset:33344
  ds_read_b128 v[124:127], v5 offset:49984
  v_mfma_f32_16x16x32_bf16 v[164:167], v[128:131], v[100:103], v[164:167]
  ds_read_b128 v[244:247], v8 offset:13520
  v_fmac_f32 v27, v41, v73
  v_mfma_f32_16x16x32_bf16 v[168:171], v[128:131], v[104:107], v[168:171]
  v_fmac_f32 v27, v42, v74
  v_fmac_f32 v27, v43, v75
  v_mfma_f32_16x16x32_bf16 v[40:43], a[112:115], v[240:243], 0
  v_fmac_f32 v27, v47, v88
  v_fmac_f32 v28, v36, v80
  v_mfma_f32_16x16x32_bf16 v[172:175], v[128:131], v[108:111], v[172:175]
  buffer_load_dwordx4 v[128:131], v4, s[32:35], s43 offen offset:0 sc1
  v_fmac_f32 v28, v37, v81
  v_fmac_f32 v28, v38, v82
  v_mfma_f32_16x16x32_bf16 v[44:47], a[176:179], v[240:243], 0
  s_waitcnt vmcnt(9)
  v_fmac_f32 v28, v39, v83
  v_fmac_f32 v28, v40, v84
  v_mfma_f32_16x16x32_bf16 v[188:191], v[132:135], v[108:111], v[188:191]
  s_add_u32 m0, s44, 68640
  v_add_u32_dpp v2, v92, v1 quad_perm:[2,2,2,2] row_mask:0xf bank_mask:0xf
  v_fmac_f32 v28, v41, v85
  v_mfma_f32_16x16x32_bf16 v[36:39], a[240:243], v[240:243], 0
  buffer_load_dwordx4 v2, s[28:31], 0 offen lds
  v_fmac_f32 v28, v42, v86
  v_mfma_f32_16x16x32_bf16 v[184:187], v[132:135], v[104:107], v[184:187]
  v_fmac_f32 v28, v43, v87
  v_fmac_f32 v28, v44, v64
  v_mfma_f32_16x16x32_bf16 v[180:183], v[132:135], v[100:103], v[180:183]
  v_fmac_f32 v28, v45, v65
  v_fmac_f32 v28, v46, v66
  v_mfma_f32_16x16x32_bf16 v[40:43], v[240:243], v[240:243], 0
  v_fmac_f32 v28, v47, v67
  v_fmac_f32 v28, v36, v68
  v_mfma_f32_16x16x32_bf16 v[176:179], v[132:135], v[96:99], v[176:179]
  buffer_load_dwordx4 v[132:135], v4, s[32:35], s43 offen offset:1024 sc1
  v_fmac_f32 v28, v37, v69
  v_fmac_f32 v28, v38, v70
  v_mfma_f32_16x16x32_bf16 v[44:47], v[60:63], v[240:243], 0
  s_waitcnt vmcnt(10) lgkmcnt(3)
  v_fmac_f32 v28, v39, v71
  v_fmac_f32 v28, v40, v72
  v_mfma_f32_16x16x32_bf16 v[160:163], v[136:139], v[112:115], v[160:163]
  s_waitcnt lgkmcnt(0)
  ds_read_b128 v[96:99], v5 offset:128
  ds_read_b128 v[100:103], v5 offset:16768
  v_mfma_f32_16x16x32_bf16 v[36:39], a[52:55], v[244:247], 0
  ds_read_b128 v[104:107], v5 offset:33408
  ds_read_b128 v[108:111], v5 offset:50048
  v_mfma_f32_16x16x32_bf16 v[164:167], v[136:139], v[116:119], v[164:167]
  ds_read_b128 v[248:251], v8 offset:14560
  v_fmac_f32 v28, v41, v73
  v_mfma_f32_16x16x32_bf16 v[168:171], v[136:139], v[120:123], v[168:171]
  s_add_u32 m0, s44, 69680
  v_add_u32_dpp v3, v92, v1 quad_perm:[3,3,3,3] row_mask:0xf bank_mask:0xf
  v_fmac_f32 v28, v42, v74
  v_fmac_f32 v28, v43, v75
  v_mfma_f32_16x16x32_bf16 v[40:43], a[116:119], v[244:247], 0
  buffer_load_dwordx4 v3, s[28:31], 0 offen lds
  v_fmac_f32 v28, v44, v88
  v_mfma_f32_16x16x32_bf16 v[172:175], v[136:139], v[124:127], v[172:175]
  buffer_load_dwordx4 v[136:139], v4, s[32:35], s43 offen offset:2048 sc1
  v_fmac_f32 v29, v36, v80
  v_fmac_f32 v29, v37, v81
  v_mfma_f32_16x16x32_bf16 v[44:47], a[180:183], v[244:247], 0
  s_waitcnt vmcnt(11)
  v_fmac_f32 v29, v38, v82
  v_fmac_f32 v29, v39, v83
  v_mfma_f32_16x16x32_bf16 v[188:191], v[140:143], v[124:127], v[188:191]
  v_fmac_f32 v29, v40, v84
  v_fmac_f32 v29, v41, v85
  v_mfma_f32_16x16x32_bf16 v[36:39], a[244:247], v[244:247], 0
  v_fmac_f32 v29, v42, v86
  v_fmac_f32 v29, v43, v87
  v_mfma_f32_16x16x32_bf16 v[184:187], v[140:143], v[120:123], v[184:187]
  v_fmac_f32 v29, v44, v64
  v_fmac_f32 v29, v45, v65
  v_mfma_f32_16x16x32_bf16 v[180:183], v[140:143], v[116:119], v[180:183]
  v_fmac_f32 v29, v46, v66
  v_fmac_f32 v29, v47, v67
  v_mfma_f32_16x16x32_bf16 v[40:43], v[244:247], v[244:247], 0
  v_fmac_f32 v29, v36, v68
  v_fmac_f32 v29, v37, v69
  v_mfma_f32_16x16x32_bf16 v[176:179], v[140:143], v[112:115], v[176:179]
  buffer_load_dwordx4 v[140:143], v4, s[32:35], s43 offen offset:3072 sc1
  v_fmac_f32 v29, v38, v70
  v_fmac_f32 v29, v39, v71
  v_mfma_f32_16x16x32_bf16 v[44:47], v[60:63], v[244:247], 0
  s_waitcnt vmcnt(11) lgkmcnt(3)
  v_fmac_f32 v29, v40, v72
  v_fmac_f32 v29, v41, v73
  v_mfma_f32_16x16x32_bf16 v[160:163], v[144:147], v[96:99], v[160:163]
  s_waitcnt lgkmcnt(0)
  ds_read_b128 v[112:115], v5 offset:192
  ds_read_b128 v[116:119], v5 offset:16832
  v_mfma_f32_16x16x32_bf16 v[36:39], a[56:59], v[248:251], 0
  s_add_u32 s43, s43, 8192
  ds_read_b128 v[120:123], v5 offset:33472
  ds_read_b128 v[124:127], v5 offset:50112
  v_mfma_f32_16x16x32_bf16 v[164:167], v[144:147], v[100:103], v[164:167]
  s_add_u32 m0, s44, 70720
  ds_read_b128 v[252:255], v8 offset:15600
  v_add_u32_dpp v2, v93, v6 quad_perm:[0,0,0,0] row_mask:0xf bank_mask:0xf
  v_mfma_f32_16x16x32_bf16 v[168:171], v[144:147], v[104:107], v[168:171]
  buffer_load_dwordx4 v2, s[28:31], 0 offen lds
  v_fmac_f32 v29, v42, v74
  v_fmac_f32 v29, v43, v75
  v_mfma_f32_16x16x32_bf16 v[40:43], a[120:123], v[248:251], 0
  v_fmac_f32 v29, v45, v88
  v_fmac_f32 v30, v36, v80
  v_mfma_f32_16x16x32_bf16 v[172:175], v[144:147], v[108:111], v[172:175]
  buffer_load_dwordx4 v[144:147], v4, s[32:35], s62 offen offset:0 sc1
  v_fmac_f32 v30, v37, v81
  v_fmac_f32 v30, v38, v82
  v_mfma_f32_16x16x32_bf16 v[44:47], a[184:187], v[248:251], 0
  s_waitcnt vmcnt(12)
  v_fmac_f32 v30, v39, v83
  v_fmac_f32 v30, v40, v84
  v_mfma_f32_16x16x32_bf16 v[188:191], v[148:151], v[108:111], v[188:191]
  v_xad_u32 v5, v7, 48, v11
  v_fmac_f32 v30, v41, v85
  v_mfma_f32_16x16x32_bf16 v[36:39], a[248:251], v[248:251], 0
  v_fmac_f32 v30, v42, v86
  v_fmac_f32 v30, v43, v87
  v_mfma_f32_16x16x32_bf16 v[184:187], v[148:151], v[104:107], v[184:187]
  v_fmac_f32 v30, v44, v64
  v_fmac_f32 v30, v45, v65
  v_mfma_f32_16x16x32_bf16 v[180:183], v[148:151], v[100:103], v[180:183]
  s_add_u32 m0, s44, 71760
  v_add_u32_dpp v3, v93, v6 quad_perm:[1,1,1,1] row_mask:0xf bank_mask:0xf
  v_fmac_f32 v30, v46, v66
  v_mfma_f32_16x16x32_bf16 v[40:43], v[248:251], v[248:251], 0
  buffer_load_dwordx4 v3, s[28:31], 0 offen lds
  v_fmac_f32 v30, v47, v67
  v_mfma_f32_16x16x32_bf16 v[176:179], v[148:151], v[96:99], v[176:179]
  buffer_load_dwordx4 v[148:151], v4, s[32:35], s62 offen offset:1024 sc1
  v_fmac_f32 v30, v36, v68
  v_fmac_f32 v30, v37, v69
  v_mfma_f32_16x16x32_bf16 v[44:47], v[60:63], v[248:251], 0
  s_waitcnt vmcnt(12) lgkmcnt(3)
  v_fmac_f32 v30, v38, v70
  v_fmac_f32 v30, v39, v71
  v_mfma_f32_16x16x32_bf16 v[160:163], v[152:155], v[112:115], v[160:163]
  s_waitcnt lgkmcnt(0)
  ds_read_b128 v[96:99], v5 offset:256
  ds_read_b128 v[100:103], v5 offset:16896
  v_mfma_f32_16x16x32_bf16 v[36:39], a[60:63], v[252:255], 0
  ds_read_b128 v[104:107], v5 offset:33536
  ds_read_b128 v[108:111], v5 offset:50176
  v_mfma_f32_16x16x32_bf16 v[164:167], v[152:155], v[116:119], v[164:167]
  ds_read_b128 v[12:15], v9 offset:0
  v_fmac_f32 v30, v40, v72
  v_mfma_f32_16x16x32_bf16 v[168:171], v[152:155], v[120:123], v[168:171]
  v_fmac_f32 v30, v41, v73
  v_fmac_f32 v30, v42, v74
  v_fmac_f32 v30, v43, v75
  v_mfma_f32_16x16x32_bf16 v[40:43], a[124:127], v[252:255], 0
  v_fmac_f32 v30, v46, v88
  v_fmac_f32 v31, v36, v80
  v_mfma_f32_16x16x32_bf16 v[172:175], v[152:155], v[124:127], v[172:175]
  buffer_load_dwordx4 v[152:155], v4, s[32:35], s62 offen offset:2048 sc1
  v_fmac_f32 v31, v37, v81
  v_fmac_f32 v31, v38, v82
  v_mfma_f32_16x16x32_bf16 v[44:47], a[188:191], v[252:255], 0
  s_waitcnt vmcnt(11)
  v_add_u32_dpp v2, v93, v6 quad_perm:[2,2,2,2] row_mask:0xf bank_mask:0xf
  v_fmac_f32 v31, v39, v83
  v_mfma_f32_16x16x32_bf16 v[188:191], v[156:159], v[124:127], v[188:191]
  s_add_u32 m0, s44, 72800
  ds_read_b128 v[80:83], v10 offset:19456
  v_fmac_f32 v31, v40, v84
  v_mfma_f32_16x16x32_bf16 v[36:39], a[252:255], v[252:255], 0
  buffer_load_dwordx4 v2, s[28:31], 0 offen lds
  v_fmac_f32 v31, v41, v85
  v_mfma_f32_16x16x32_bf16 v[184:187], v[156:159], v[120:123], v[184:187]
  v_fmac_f32 v31, v42, v86
  v_fmac_f32 v31, v43, v87
  v_mfma_f32_16x16x32_bf16 v[180:183], v[156:159], v[116:119], v[180:183]
  ds_read_b128 v[84:87], v10 offset:20480
  v_fmac_f32 v31, v44, v64
  v_mfma_f32_16x16x32_bf16 v[40:43], v[252:255], v[252:255], 0
  v_fmac_f32 v31, v45, v65
  v_fmac_f32 v31, v46, v66
  v_mfma_f32_16x16x32_bf16 v[176:179], v[156:159], v[112:115], v[176:179]
  buffer_load_dwordx4 v[156:159], v4, s[32:35], s62 offen offset:3072 sc1
  v_fmac_f32 v31, v47, v67
  v_fmac_f32 v31, v36, v68
  v_mfma_f32_16x16x32_bf16 v[44:47], v[60:63], v[252:255], 0
  s_waitcnt vmcnt(12) lgkmcnt(5)
  ds_read_b128 v[64:67], v10 offset:21504
  v_fmac_f32 v31, v37, v69
  v_mfma_f32_16x16x32_bf16 v[160:163], v[128:131], v[96:99], v[160:163]
  s_waitcnt lgkmcnt(3)
  ds_read_b128 v[112:115], v5 offset:320
  ds_read_b128 v[116:119], v5 offset:16960
  v_fmac_f32 v31, v38, v70
  v_fmac_f32 v31, v39, v71
  v_mfma_f32_16x16x32_bf16 v[36:39], a[0:3], v[12:15], 0
  s_add_u32 s62, s62, 8192
  ds_read_b128 v[120:123], v5 offset:33600
  ds_read_b128 v[124:127], v5 offset:50240
  v_mfma_f32_16x16x32_bf16 v[164:167], v[128:131], v[100:103], v[164:167]
  ds_read_b128 v[68:71], v10 offset:22528
  ds_read_b128 v[32:35], v9 offset:1040
  v_fmac_f32 v31, v40, v72
  v_fmac_f32 v31, v41, v73
  v_fmac_f32 v31, v42, v74
  v_fmac_f32 v31, v43, v75
  v_mfma_f32_16x16x32_bf16 v[40:43], a[64:67], v[12:15], 0
  s_add_u32 m0, s44, 73840
  ds_read_b128 v[72:75], v10 offset:23552
  v_add_u32_dpp v3, v93, v6 quad_perm:[3,3,3,3] row_mask:0xf bank_mask:0xf
  v_mfma_f32_16x16x32_bf16 v[168:171], v[128:131], v[104:107], v[168:171]
  buffer_load_dwordx4 v3, s[28:31], 0 offen lds
  v_fmac_f32 v31, v47, v88
  v_mfma_f32_16x16x32_bf16 v[44:47], a[128:131], v[12:15], 0
  v_fmac_f32 v16, v36, v76
  v_fmac_f32 v16, v37, v77
  v_mfma_f32_16x16x32_bf16 v[172:175], v[128:131], v[108:111], v[172:175]
  buffer_load_dwordx4 v[128:131], v4, s[32:35], s43 offen offset:0 sc1
  v_fmac_f32 v16, v38, v78
  v_fmac_f32 v16, v39, v79
  v_mfma_f32_16x16x32_bf16 v[36:39], a[192:195], v[12:15], 0
  s_waitcnt lgkmcnt(9)
  v_fmac_f32 v16, v40, v80
  v_fmac_f32 v16, v41, v81
  v_fmac_f32 v16, v42, v82
  v_fmac_f32 v16, v43, v83
  v_mfma_f32_16x16x32_bf16 v[40:43], v[192:195], v[12:15], 0
  s_waitcnt vmcnt(12)
  s_waitcnt lgkmcnt(8)
  v_fmac_f32 v16, v44, v84
  v_fmac_f32 v16, v45, v85
  v_mfma_f32_16x16x32_bf16 v[188:191], v[132:135], v[108:111], v[188:191]
  v_fmac_f32 v16, v46, v86
  v_fmac_f32 v16, v47, v87
  v_mfma_f32_16x16x32_bf16 v[44:47], v[12:15], v[12:15], 0
  s_waitcnt lgkmcnt(7)
  v_fmac_f32 v16, v36, v64
  v_fmac_f32 v16, v37, v65
  v_mfma_f32_16x16x32_bf16 v[184:187], v[132:135], v[104:107], v[184:187]
  v_fmac_f32 v16, v38, v66
  v_fmac_f32 v16, v39, v67
  v_mfma_f32_16x16x32_bf16 v[36:39], v[48:51], v[12:15], 0
  s_waitcnt lgkmcnt(2)
  v_fmac_f32 v16, v40, v68
  v_fmac_f32 v16, v41, v69
  v_mfma_f32_16x16x32_bf16 v[180:183], v[132:135], v[100:103], v[180:183]
  s_waitcnt lgkmcnt(1)
  v_fmac_f32 v16, v42, v70
  v_fmac_f32 v16, v43, v71
  v_mfma_f32_16x16x32_bf16 v[40:43], a[4:7], v[32:35], 0
  ds_read_b128 v[12:15], v9 offset:2080
  s_waitcnt lgkmcnt(1)
  v_fmac_f32 v16, v44, v72
  v_mfma_f32_16x16x32_bf16 v[176:179], v[132:135], v[96:99], v[176:179]
  s_add_u32 m0, s44, 74880
  buffer_load_dwordx4 v[132:135], v4, s[32:35], s43 offen offset:1024 sc1
  v_add_u32_dpp v2, v94, v6 quad_perm:[0,0,0,0] row_mask:0xf bank_mask:0xf
  v_fmac_f32 v16, v45, v73
  v_fmac_f32 v16, v46, v74
  v_fmac_f32 v16, v47, v75
  v_mfma_f32_16x16x32_bf16 v[44:47], a[68:71], v[32:35], 0
  s_waitcnt vmcnt(11)
  buffer_load_dwordx4 v2, s[28:31], 0 offen lds
  v_fmac_f32 v16, v36, v89
  v_mfma_f32_16x16x32_bf16 v[160:163], v[136:139], v[112:115], v[160:163]
  ds_read_b128 v[96:99], v5 offset:384
  ds_read_b128 v[100:103], v5 offset:17024
  v_mfma_f32_16x16x32_bf16 v[36:39], a[132:135], v[32:35], 0
  ds_read_b128 v[104:107], v5 offset:33664
  ds_read_b128 v[108:111], v5 offset:50304
  v_mfma_f32_16x16x32_bf16 v[164:167], v[136:139], v[116:119], v[164:167]
  v_fmac_f32 v17, v40, v76
  v_fmac_f32 v17, v41, v77
  v_fmac_f32 v17, v42, v78
  v_fmac_f32 v17, v43, v79
  v_mfma_f32_16x16x32_bf16 v[40:43], a[196:199], v[32:35], 0
  v_fmac_f32 v17, v44, v80
  v_fmac_f32 v17, v45, v81
  v_fmac_f32 v17, v46, v82
  v_fmac_f32 v17, v47, v83
  v_mfma_f32_16x16x32_bf16 v[44:47], v[196:199], v[32:35], 0
  v_fmac_f32 v17, v36, v84
  v_fmac_f32 v17, v37, v85
  v_mfma_f32_16x16x32_bf16 v[168:171], v[136:139], v[120:123], v[168:171]
  v_fmac_f32 v17, v38, v86
  v_fmac_f32 v17, v39, v87
  v_mfma_f32_16x16x32_bf16 v[36:39], v[32:35], v[32:35], 0
  v_fmac_f32 v17, v40, v64
  v_fmac_f32 v17, v41, v65
  v_mfma_f32_16x16x32_bf16 v[172:175], v[136:139], v[124:127], v[172:175]
  buffer_load_dwordx4 v[136:139], v4, s[32:35], s43 offen offset:2048 sc1
  v_fmac_f32 v17, v42, v66
  v_fmac_f32 v17, v43, v67
  v_mfma_f32_16x16x32_bf16 v[40:43], v[48:51], v[32:35], 0
  s_waitcnt vmcnt(12)
  v_fmac_f32 v17, v44, v68
  v_fmac_f32 v17, v45, v69
  v_mfma_f32_16x16x32_bf16 v[188:191], v[140:143], v[124:127], v[188:191]
  s_waitcnt lgkmcnt(4)
  v_fmac_f32 v17, v46, v70
  v_fmac_f32 v17, v47, v71
  v_mfma_f32_16x16x32_bf16 v[44:47], a[8:11], v[12:15], 0
  ds_read_b128 v[32:35], v9 offset:3120
  v_fmac_f32 v17, v36, v72
  v_mfma_f32_16x16x32_bf16 v[184:187], v[140:143], v[120:123], v[184:187]
  s_add_u32 m0, s44, 75920
  v_add_u32_dpp v3, v94, v6 quad_perm:[1,1,1,1] row_mask:0xf bank_mask:0xf
  v_fmac_f32 v17, v37, v73
  v_fmac_f32 v17, v38, v74
  v_fmac_f32 v17, v39, v75
  v_mfma_f32_16x16x32_bf16 v[36:39], a[72:75], v[12:15], 0
  buffer_load_dwordx4 v3, s[28:31], 0 offen lds
  v_fmac_f32 v17, v41, v89
  v_mfma_f32_16x16x32_bf16 v[180:183], v[140:143], v[116:119], v[180:183]
  v_fmac_f32 v18, v44, v76
  v_fmac_f32 v18, v45, v77
  v_mfma_f32_16x16x32_bf16 v[40:43], a[136:139], v[12:15], 0
  v_fmac_f32 v18, v46, v78
  v_fmac_f32 v18, v47, v79
  v_mfma_f32_16x16x32_bf16 v[176:179], v[140:143], v[112:115], v[176:179]
  buffer_load_dwordx4 v[140:143], v4, s[32:35], s43 offen offset:3072 sc1
  v_fmac_f32 v18, v36, v80
  v_fmac_f32 v18, v37, v81
  v_mfma_f32_16x16x32_bf16 v[44:47], a[200:203], v[12:15], 0
  s_add_u32 s43, s43, 8192
  v_fmac_f32 v18, v38, v82
  v_fmac_f32 v18, v39, v83
  v_mfma_f32_16x16x32_bf16 v[36:39], v[200:203], v[12:15], 0
  s_waitcnt vmcnt(12) lgkmcnt(3)
  v_fmac_f32 v18, v40, v84
  v_fmac_f32 v18, v41, v85
  v_mfma_f32_16x16x32_bf16 v[160:163], v[144:147], v[96:99], v[160:163]
  ds_read_b128 v[112:115], v5 offset:448
  ds_read_b128 v[116:119], v5 offset:17088
  v_fmac_f32 v18, v42, v86
  v_fmac_f32 v18, v43, v87
  v_mfma_f32_16x16x32_bf16 v[40:43], v[12:15], v[12:15], 0
  ds_read_b128 v[120:123], v5 offset:33728
  ds_read_b128 v[124:127], v5 offset:50368
  v_mfma_f32_16x16x32_bf16 v[164:167], v[144:147], v[100:103], v[164:167]
  v_fmac_f32 v18, v44, v64
  v_fmac_f32 v18, v45, v65
  v_fmac_f32 v18, v46, v66
  v_fmac_f32 v18, v47, v67
  v_mfma_f32_16x16x32_bf16 v[44:47], v[48:51], v[12:15], 0
  s_waitcnt lgkmcnt(5)
  v_fmac_f32 v18, v36, v68
  v_fmac_f32 v18, v37, v69
  v_mfma_f32_16x16x32_bf16 v[168:171], v[144:147], v[104:107], v[168:171]
  s_waitcnt lgkmcnt(4)
  v_fmac_f32 v18, v38, v70
  v_fmac_f32 v18, v39, v71
  v_mfma_f32_16x16x32_bf16 v[36:39], a[12:15], v[32:35], 0
  v_xor_b32 v9, 16, v9
  ds_read_b128 v[12:15], v9 offset:4160
  v_fmac_f32 v18, v40, v72
  v_mfma_f32_16x16x32_bf16 v[172:175], v[144:147], v[108:111], v[172:175]
  s_add_u32 m0, s44, 76960
  buffer_load_dwordx4 v[144:147], v4, s[32:35], s62 offen offset:0 sc1
  v_add_u32_dpp v2, v94, v6 quad_perm:[2,2,2,2] row_mask:0xf bank_mask:0xf
  v_fmac_f32 v18, v41, v73
  v_fmac_f32 v18, v42, v74
  v_fmac_f32 v18, v43, v75
  v_mfma_f32_16x16x32_bf16 v[40:43], a[76:79], v[32:35], 0
  s_waitcnt vmcnt(11)
  buffer_load_dwordx4 v2, s[28:31], 0 offen lds
  v_fmac_f32 v18, v46, v89
  v_mfma_f32_16x16x32_bf16 v[188:191], v[148:151], v[108:111], v[188:191]
  v_xad_u32 v5, v7, 32, v11
  v_fmac_f32 v19, v36, v76
  v_mfma_f32_16x16x32_bf16 v[44:47], a[140:143], v[32:35], 0
  v_fmac_f32 v19, v37, v77
  v_fmac_f32 v19, v38, v78
  v_mfma_f32_16x16x32_bf16 v[184:187], v[148:151], v[104:107], v[184:187]
  v_fmac_f32 v19, v39, v79
  v_fmac_f32 v19, v40, v80
  v_mfma_f32_16x16x32_bf16 v[36:39], a[204:207], v[32:35], 0
  v_fmac_f32 v19, v41, v81
  v_fmac_f32 v19, v42, v82
  v_fmac_f32 v19, v43, v83
  v_mfma_f32_16x16x32_bf16 v[40:43], v[204:207], v[32:35], 0
  v_fmac_f32 v19, v44, v84
  v_fmac_f32 v19, v45, v85
  v_mfma_f32_16x16x32_bf16 v[180:183], v[148:151], v[100:103], v[180:183]
  v_fmac_f32 v19, v46, v86
  v_fmac_f32 v19, v47, v87
  v_mfma_f32_16x16x32_bf16 v[44:47], v[32:35], v[32:35], 0
  v_fmac_f32 v19, v36, v64
  v_fmac_f32 v19, v37, v65
  v_mfma_f32_16x16x32_bf16 v[176:179], v[148:151], v[96:99], v[176:179]
  buffer_load_dwordx4 v[148:151], v4, s[32:35], s62 offen offset:1024 sc1
  v_fmac_f32 v19, v38, v66
  v_fmac_f32 v19, v39, v67
  v_mfma_f32_16x16x32_bf16 v[36:39], v[48:51], v[32:35], 0
  s_waitcnt vmcnt(12) lgkmcnt(3)
  v_fmac_f32 v19, v40, v68
  v_fmac_f32 v19, v41, v69
  v_mfma_f32_16x16x32_bf16 v[160:163], v[152:155], v[112:115], v[160:163]
  s_waitcnt lgkmcnt(0)
  ds_read_b128 v[96:99], v5 offset:512
  ds_read_b128 v[100:103], v5 offset:17152
  v_fmac_f32 v19, v42, v70
  v_fmac_f32 v19, v43, v71
  v_mfma_f32_16x16x32_bf16 v[40:43], a[16:19], v[12:15], 0
  ds_read_b128 v[104:107], v5 offset:33792
  ds_read_b128 v[108:111], v5 offset:50432
  v_mfma_f32_16x16x32_bf16 v[164:167], v[152:155], v[116:119], v[164:167]
  s_add_u32 m0, s44, 78000
  ds_read_b128 v[32:35], v9 offset:5200
  v_add_u32_dpp v3, v94, v6 quad_perm:[3,3,3,3] row_mask:0xf bank_mask:0xf
  v_fmac_f32 v19, v44, v72
  v_fmac_f32 v19, v45, v73
  v_fmac_f32 v19, v46, v74
  v_fmac_f32 v19, v47, v75
  v_mfma_f32_16x16x32_bf16 v[44:47], a[80:83], v[12:15], 0
  buffer_load_dwordx4 v3, s[28:31], 0 offen lds
  v_fmac_f32 v19, v39, v89
  v_mfma_f32_16x16x32_bf16 v[168:171], v[152:155], v[120:123], v[168:171]
  v_fmac_f32 v20, v40, v76
  v_fmac_f32 v20, v41, v77
  v_mfma_f32_16x16x32_bf16 v[36:39], a[144:147], v[12:15], 0
  v_fmac_f32 v20, v42, v78
  v_fmac_f32 v20, v43, v79
  v_mfma_f32_16x16x32_bf16 v[172:175], v[152:155], v[124:127], v[172:175]
  buffer_load_dwordx4 v[152:155], v4, s[32:35], s62 offen offset:2048 sc1
  v_fmac_f32 v20, v44, v80
  v_fmac_f32 v20, v45, v81
  v_mfma_f32_16x16x32_bf16 v[40:43], a[208:211], v[12:15], 0
  v_fmac_f32 v20, v46, v82
  v_fmac_f32 v20, v47, v83
  v_mfma_f32_16x16x32_bf16 v[44:47], v[208:211], v[12:15], 0
  s_waitcnt vmcnt(12)
  v_fmac_f32 v20, v36, v84
  v_fmac_f32 v20, v37, v85
  v_mfma_f32_16x16x32_bf16 v[188:191], v[156:159], v[124:127], v[188:191]
  v_fmac_f32 v20, v38, v86
  v_fmac_f32 v20, v39, v87
  v_mfma_f32_16x16x32_bf16 v[36:39], v[12:15], v[12:15], 0
  v_fmac_f32 v20, v40, v64
  v_fmac_f32 v20, v41, v65
  v_mfma_f32_16x16x32_bf16 v[184:187], v[156:159], v[120:123], v[184:187]
  v_fmac_f32 v20, v42, v66
  v_fmac_f32 v20, v43, v67
  v_mfma_f32_16x16x32_bf16 v[40:43], v[52:55], v[12:15], 0
  v_fmac_f32 v20, v44, v68
  v_fmac_f32 v20, v45, v69
  v_mfma_f32_16x16x32_bf16 v[180:183], v[156:159], v[116:119], v[180:183]
  s_waitcnt lgkmcnt(0)
  v_fmac_f32 v20, v46, v70
  v_fmac_f32 v20, v47, v71
  v_mfma_f32_16x16x32_bf16 v[44:47], a[20:23], v[32:35], 0
  s_add_u32 m0, s44, 79040
  ds_read_b128 v[12:15], v9 offset:6240
  v_add_u32_dpp v2, v95, v1 quad_perm:[0,0,0,0] row_mask:0xf bank_mask:0xf
  v_mfma_f32_16x16x32_bf16 v[176:179], v[156:159], v[112:115], v[176:179]
  buffer_load_dwordx4 v2, s[28:31], 0 offen lds
  buffer_load_dwordx4 v[156:159], v4, s[32:35], s62 offen offset:3072 sc1
  v_fmac_f32 v20, v36, v72
  v_fmac_f32 v20, v37, v73
  v_fmac_f32 v20, v38, v74
  v_fmac_f32 v20, v39, v75
  v_mfma_f32_16x16x32_bf16 v[36:39], a[84:87], v[32:35], 0
  s_waitcnt vmcnt(12)
  v_fmac_f32 v20, v40, v89
  v_fmac_f32 v21, v44, v76
  v_mfma_f32_16x16x32_bf16 v[160:163], v[128:131], v[96:99], v[160:163]
  s_add_u32 s62, s62, 8192
  ds_read_b128 v[112:115], v5 offset:576
  ds_read_b128 v[116:119], v5 offset:17216
  v_mfma_f32_16x16x32_bf16 v[40:43], a[148:151], v[32:35], 0
  ds_read_b128 v[120:123], v5 offset:33856
  ds_read_b128 v[124:127], v5 offset:50496
  v_mfma_f32_16x16x32_bf16 v[164:167], v[128:131], v[100:103], v[164:167]
  v_fmac_f32 v21, v45, v77
  v_fmac_f32 v21, v46, v78
  v_fmac_f32 v21, v47, v79
  v_mfma_f32_16x16x32_bf16 v[44:47], a[212:215], v[32:35], 0
  v_fmac_f32 v21, v36, v80
  v_fmac_f32 v21, v37, v81
  v_fmac_f32 v21, v38, v82
  v_fmac_f32 v21, v39, v83
  v_mfma_f32_16x16x32_bf16 v[36:39], v[212:215], v[32:35], 0
  v_fmac_f32 v21, v40, v84
  v_fmac_f32 v21, v41, v85
  v_mfma_f32_16x16x32_bf16 v[168:171], v[128:131], v[104:107], v[168:171]
  v_fmac_f32 v21, v42, v86
  v_fmac_f32 v21, v43, v87
  v_mfma_f32_16x16x32_bf16 v[40:43], v[32:35], v[32:35], 0
  v_fmac_f32 v21, v44, v64
  v_fmac_f32 v21, v45, v65
  v_mfma_f32_16x16x32_bf16 v[172:175], v[128:131], v[108:111], v[172:175]
  buffer_load_dwordx4 v[128:131], v4, s[32:35], s43 offen offset:0 sc1
  v_fmac_f32 v21, v46, v66
  v_fmac_f32 v21, v47, v67
  v_mfma_f32_16x16x32_bf16 v[44:47], v[52:55], v[32:35], 0
  s_waitcnt vmcnt(12)
  v_fmac_f32 v21, v36, v68
  v_fmac_f32 v21, v37, v69
  v_mfma_f32_16x16x32_bf16 v[188:191], v[132:135], v[108:111], v[188:191]
  s_waitcnt lgkmcnt(4)
  v_fmac_f32 v21, v38, v70
  v_fmac_f32 v21, v39, v71
  v_mfma_f32_16x16x32_bf16 v[36:39], a[24:27], v[12:15], 0
  s_add_u32 m0, s44, 80080
  ds_read_b128 v[32:35], v9 offset:7280
  v_add_u32_dpp v3, v95, v1 quad_perm:[1,1,1,1] row_mask:0xf bank_mask:0xf
  v_mfma_f32_16x16x32_bf16 v[184:187], v[132:135], v[104:107], v[184:187]
  buffer_load_dwordx4 v3, s[28:31], 0 offen lds
  v_fmac_f32 v21, v40, v72
  v_fmac_f32 v21, v41, v73
  v_fmac_f32 v21, v42, v74
  v_fmac_f32 v21, v43, v75
  v_mfma_f32_16x16x32_bf16 v[40:43], a[88:91], v[12:15], 0
  v_fmac_f32 v21, v45, v89
  v_fmac_f32 v22, v36, v76
  v_mfma_f32_16x16x32_bf16 v[180:183], v[132:135], v[100:103], v[180:183]
  v_fmac_f32 v22, v37, v77
  v_fmac_f32 v22, v38, v78
  v_mfma_f32_16x16x32_bf16 v[44:47], a[152:155], v[12:15], 0
  v_fmac_f32 v22, v39, v79
  v_mfma_f32_16x16x32_bf16 v[176:179], v[132:135], v[96:99], v[176:179]
  buffer_load_dwordx4 v[132:135], v4, s[32:35], s43 offen offset:1024 sc1
  v_fmac_f32 v22, v40, v80
  v_fmac_f32 v22, v41, v81
  v_mfma_f32_16x16x32_bf16 v[36:39], a[216:219], v[12:15], 0
  v_fmac_f32 v22, v42, v82
  v_fmac_f32 v22, v43, v83
  v_mfma_f32_16x16x32_bf16 v[40:43], v[216:219], v[12:15], 0
  s_waitcnt vmcnt(12) lgkmcnt(3)
  v_fmac_f32 v22, v44, v84
  v_fmac_f32 v22, v45, v85
  v_mfma_f32_16x16x32_bf16 v[160:163], v[136:139], v[112:115], v[160:163]
  ds_read_b128 v[96:99], v5 offset:640
  ds_read_b128 v[100:103], v5 offset:17280
  v_fmac_f32 v22, v46, v86
  v_fmac_f32 v22, v47, v87
  v_mfma_f32_16x16x32_bf16 v[44:47], v[12:15], v[12:15], 0
  ds_read_b128 v[104:107], v5 offset:33920
  ds_read_b128 v[108:111], v5 offset:50560
  v_mfma_f32_16x16x32_bf16 v[164:167], v[136:139], v[116:119], v[164:167]
  v_fmac_f32 v22, v36, v64
  v_fmac_f32 v22, v37, v65
  v_fmac_f32 v22, v38, v66
  v_fmac_f32 v22, v39, v67
  v_mfma_f32_16x16x32_bf16 v[36:39], v[52:55], v[12:15], 0
  s_waitcnt lgkmcnt(5)
  v_fmac_f32 v22, v40, v68
  v_fmac_f32 v22, v41, v69
  v_mfma_f32_16x16x32_bf16 v[168:171], v[136:139], v[120:123], v[168:171]
  s_waitcnt lgkmcnt(4)
  v_fmac_f32 v22, v42, v70
  v_fmac_f32 v22, v43, v71
  v_mfma_f32_16x16x32_bf16 v[40:43], a[28:31], v[32:35], 0
  s_add_u32 m0, s44, 81120
  ds_read_b128 v[12:15], v9 offset:8320
  v_add_u32_dpp v2, v95, v1 quad_perm:[2,2,2,2] row_mask:0xf bank_mask:0xf
  v_mfma_f32_16x16x32_bf16 v[172:175], v[136:139], v[124:127], v[172:175]
  buffer_load_dwordx4 v2, s[28:31], 0 offen lds
  buffer_load_dwordx4 v[136:139], v4, s[32:35], s43 offen offset:2048 sc1
  v_fmac_f32 v22, v44, v72
  v_fmac_f32 v22, v45, v73
  v_fmac_f32 v22, v46, v74
  v_fmac_f32 v22, v47, v75
  v_mfma_f32_16x16x32_bf16 v[44:47], a[92:95], v[32:35], 0
  s_waitcnt vmcnt(12)
  v_fmac_f32 v22, v38, v89
  v_fmac_f32 v23, v40, v76
  v_mfma_f32_16x16x32_bf16 v[188:191], v[140:143], v[124:127], v[188:191]
  v_fmac_f32 v23, v41, v77
  v_fmac_f32 v23, v42, v78
  v_mfma_f32_16x16x32_bf16 v[36:39], a[156:159], v[32:35], 0
  v_fmac_f32 v23, v43, v79
  v_fmac_f32 v23, v44, v80
  v_mfma_f32_16x16x32_bf16 v[184:187], v[140:143], v[120:123], v[184:187]
  v_fmac_f32 v23, v45, v81
  v_fmac_f32 v23, v46, v82
  v_mfma_f32_16x16x32_bf16 v[40:43], a[220:223], v[32:35], 0
  v_fmac_f32 v23, v47, v83
  v_mfma_f32_16x16x32_bf16 v[44:47], v[220:223], v[32:35], 0
  v_fmac_f32 v23, v36, v84
  v_fmac_f32 v23, v37, v85
  v_mfma_f32_16x16x32_bf16 v[180:183], v[140:143], v[116:119], v[180:183]
  v_fmac_f32 v23, v38, v86
  v_fmac_f32 v23, v39, v87
  v_mfma_f32_16x16x32_bf16 v[36:39], v[32:35], v[32:35], 0
  v_fmac_f32 v23, v40, v64
  v_fmac_f32 v23, v41, v65
  v_mfma_f32_16x16x32_bf16 v[176:179], v[140:143], v[112:115], v[176:179]
  buffer_load_dwordx4 v[140:143], v4, s[32:35], s43 offen offset:3072 sc1
  v_fmac_f32 v23, v42, v66
  v_fmac_f32 v23, v43, v67
  v_mfma_f32_16x16x32_bf16 v[40:43], v[52:55], v[32:35], 0
  s_waitcnt vmcnt(12) lgkmcnt(3)
  v_fmac_f32 v23, v44, v68
  v_fmac_f32 v23, v45, v69
  v_mfma_f32_16x16x32_bf16 v[160:163], v[144:147], v[96:99], v[160:163]
  s_waitcnt lgkmcnt(0)
  ds_read_b128 v[112:115], v5 offset:704
  ds_read_b128 v[116:119], v5 offset:17344
  v_fmac_f32 v23, v46, v70
  v_fmac_f32 v23, v47, v71
  v_mfma_f32_16x16x32_bf16 v[44:47], a[32:35], v[12:15], 0
  s_add_u32 s43, s43, 8192
  ds_read_b128 v[120:123], v5 offset:33984
  ds_read_b128 v[124:127], v5 offset:50624
  v_mfma_f32_16x16x32_bf16 v[164:167], v[144:147], v[100:103], v[164:167]
  s_add_u32 m0, s44, 82160
  ds_read_b128 v[32:35], v9 offset:9360
  v_add_u32_dpp v3, v95, v1 quad_perm:[3,3,3,3] row_mask:0xf bank_mask:0xf
  v_fmac_f32 v23, v36, v72
  v_fmac_f32 v23, v37, v73
  v_fmac_f32 v23, v38, v74
  v_fmac_f32 v23, v39, v75
  v_mfma_f32_16x16x32_bf16 v[36:39], a[96:99], v[12:15], 0
  buffer_load_dwordx4 v3, s[28:31], 0 offen lds
  v_fmac_f32 v23, v43, v89
  v_mfma_f32_16x16x32_bf16 v[168:171], v[144:147], v[104:107], v[168:171]
  v_fmac_f32 v24, v44, v76
  v_fmac_f32 v24, v45, v77
  v_mfma_f32_16x16x32_bf16 v[40:43], a[160:163], v[12:15], 0
  v_fmac_f32 v24, v46, v78
  v_fmac_f32 v24, v47, v79
  v_mfma_f32_16x16x32_bf16 v[172:175], v[144:147], v[108:111], v[172:175]
  buffer_load_dwordx4 v[144:147], v4, s[32:35], s62 offen offset:0 sc1
  v_fmac_f32 v24, v36, v80
  v_fmac_f32 v24, v37, v81
  v_mfma_f32_16x16x32_bf16 v[44:47], a[224:227], v[12:15], 0
  v_fmac_f32 v24, v38, v82
  v_fmac_f32 v24, v39, v83
  v_mfma_f32_16x16x32_bf16 v[36:39], v[224:227], v[12:15], 0
  s_waitcnt vmcnt(12)
  v_fmac_f32 v24, v40, v84
  v_fmac_f32 v24, v41, v85
  v_mfma_f32_16x16x32_bf16 v[188:191], v[148:151], v[108:111], v[188:191]
  v_xad_u32 v5, v7, 16, v11
  v_fmac_f32 v24, v42, v86
  v_fmac_f32 v24, v43, v87
  v_mfma_f32_16x16x32_bf16 v[40:43], v[12:15], v[12:15], 0
  v_fmac_f32 v24, v44, v64
  v_fmac_f32 v24, v45, v65
  v_mfma_f32_16x16x32_bf16 v[184:187], v[148:151], v[104:107], v[184:187]
  v_fmac_f32 v24, v46, v66
  v_fmac_f32 v24, v47, v67
  v_mfma_f32_16x16x32_bf16 v[44:47], v[56:59], v[12:15], 0
  v_fmac_f32 v24, v36, v68
  v_fmac_f32 v24, v37, v69
  v_mfma_f32_16x16x32_bf16 v[180:183], v[148:151], v[100:103], v[180:183]
  s_waitcnt lgkmcnt(0)
  v_fmac_f32 v24, v38, v70
  v_fmac_f32 v24, v39, v71
  v_mfma_f32_16x16x32_bf16 v[36:39], a[36:39], v[32:35], 0
  ds_read_b128 v[12:15], v9 offset:10400
  v_fmac_f32 v24, v40, v72
  v_mfma_f32_16x16x32_bf16 v[176:179], v[148:151], v[96:99], v[176:179]
  buffer_load_dwordx4 v[148:151], v4, s[32:35], s62 offen offset:1024 sc1
  v_fmac_f32 v24, v41, v73
  v_fmac_f32 v24, v42, v74
  v_fmac_f32 v24, v43, v75
  v_mfma_f32_16x16x32_bf16 v[40:43], a[100:103], v[32:35], 0
  s_waitcnt vmcnt(11)
  v_fmac_f32 v24, v44, v89
  v_fmac_f32 v25, v36, v76
  v_mfma_f32_16x16x32_bf16 v[160:163], v[152:155], v[112:115], v[160:163]
  ds_read_b128 v[96:99], v5 offset:768
  ds_read_b128 v[100:103], v5 offset:17408
  v_mfma_f32_16x16x32_bf16 v[44:47], a[164:167], v[32:35], 0
  ds_read_b128 v[104:107], v5 offset:34048
  ds_read_b128 v[108:111], v5 offset:50688
  v_mfma_f32_16x16x32_bf16 v[164:167], v[152:155], v[116:119], v[164:167]
  v_fmac_f32 v25, v37, v77
  v_fmac_f32 v25, v38, v78
  v_fmac_f32 v25, v39, v79
  v_mfma_f32_16x16x32_bf16 v[36:39], a[228:231], v[32:35], 0
  v_fmac_f32 v25, v40, v80
  v_fmac_f32 v25, v41, v81
  v_fmac_f32 v25, v42, v82
  v_fmac_f32 v25, v43, v83
  v_mfma_f32_16x16x32_bf16 v[40:43], v[228:231], v[32:35], 0
  v_fmac_f32 v25, v44, v84
  v_fmac_f32 v25, v45, v85
  v_mfma_f32_16x16x32_bf16 v[168:171], v[152:155], v[120:123], v[168:171]
  v_fmac_f32 v25, v46, v86
  v_fmac_f32 v25, v47, v87
  v_mfma_f32_16x16x32_bf16 v[44:47], v[32:35], v[32:35], 0
  v_fmac_f32 v25, v36, v64
  v_fmac_f32 v25, v37, v65
  v_mfma_f32_16x16x32_bf16 v[172:175], v[152:155], v[124:127], v[172:175]
  buffer_load_dwordx4 v[152:155], v4, s[32:35], s62 offen offset:2048 sc1
  v_fmac_f32 v25, v38, v66
  v_fmac_f32 v25, v39, v67
  v_mfma_f32_16x16x32_bf16 v[36:39], v[56:59], v[32:35], 0
  s_waitcnt vmcnt(10)
  v_fmac_f32 v25, v40, v68
  v_fmac_f32 v25, v41, v69
  v_mfma_f32_16x16x32_bf16 v[188:191], v[156:159], v[124:127], v[188:191]
  s_waitcnt lgkmcnt(4)
  v_fmac_f32 v25, v42, v70
  v_fmac_f32 v25, v43, v71
  v_mfma_f32_16x16x32_bf16 v[40:43], a[40:43], v[12:15], 0
  ds_read_b128 v[32:35], v9 offset:11440
  v_fmac_f32 v25, v44, v72
  v_mfma_f32_16x16x32_bf16 v[184:187], v[156:159], v[120:123], v[184:187]
  v_fmac_f32 v25, v45, v73
  v_fmac_f32 v25, v46, v74
  v_fmac_f32 v25, v47, v75
  v_mfma_f32_16x16x32_bf16 v[44:47], a[104:107], v[12:15], 0
  v_fmac_f32 v25, v37, v89
  v_fmac_f32 v26, v40, v76
  v_mfma_f32_16x16x32_bf16 v[180:183], v[156:159], v[116:119], v[180:183]
  v_fmac_f32 v26, v41, v77
  v_fmac_f32 v26, v42, v78
  v_mfma_f32_16x16x32_bf16 v[36:39], a[168:171], v[12:15], 0
  v_fmac_f32 v26, v43, v79
  v_mfma_f32_16x16x32_bf16 v[176:179], v[156:159], v[112:115], v[176:179]
  buffer_load_dwordx4 v[156:159], v4, s[32:35], s62 offen offset:3072 sc1
  v_fmac_f32 v26, v44, v80
  v_fmac_f32 v26, v45, v81
  v_mfma_f32_16x16x32_bf16 v[40:43], a[232:235], v[12:15], 0
  s_add_u32 s62, s62, 8192
  v_fmac_f32 v26, v46, v82
  v_fmac_f32 v26, v47, v83
  v_mfma_f32_16x16x32_bf16 v[44:47], v[232:235], v[12:15], 0
  s_waitcnt vmcnt(10) lgkmcnt(3)
  v_fmac_f32 v26, v36, v84
  v_fmac_f32 v26, v37, v85
  v_mfma_f32_16x16x32_bf16 v[160:163], v[128:131], v[96:99], v[160:163]
  ds_read_b128 v[112:115], v5 offset:832
  ds_read_b128 v[116:119], v5 offset:17472
  v_fmac_f32 v26, v38, v86
  v_fmac_f32 v26, v39, v87
  v_mfma_f32_16x16x32_bf16 v[36:39], v[12:15], v[12:15], 0
  ds_read_b128 v[120:123], v5 offset:34112
  ds_read_b128 v[124:127], v5 offset:50752
  v_mfma_f32_16x16x32_bf16 v[164:167], v[128:131], v[100:103], v[164:167]
  v_fmac_f32 v26, v40, v64
  v_fmac_f32 v26, v41, v65
  v_fmac_f32 v26, v42, v66
  v_fmac_f32 v26, v43, v67
  v_mfma_f32_16x16x32_bf16 v[40:43], v[56:59], v[12:15], 0
  s_waitcnt lgkmcnt(5)
  v_fmac_f32 v26, v44, v68
  v_fmac_f32 v26, v45, v69
  v_mfma_f32_16x16x32_bf16 v[168:171], v[128:131], v[104:107], v[168:171]
  s_waitcnt lgkmcnt(4)
  v_fmac_f32 v26, v46, v70
  v_fmac_f32 v26, v47, v71
  v_mfma_f32_16x16x32_bf16 v[44:47], a[44:47], v[32:35], 0
  v_xor_b32 v9, 16, v9
  ds_read_b128 v[12:15], v9 offset:12480
  v_fmac_f32 v26, v36, v72
  v_mfma_f32_16x16x32_bf16 v[172:175], v[128:131], v[108:111], v[172:175]
  buffer_load_dwordx4 v[128:131], v4, s[32:35], s43 offen offset:0 sc1
  v_fmac_f32 v26, v37, v73
  v_fmac_f32 v26, v38, v74
  v_fmac_f32 v26, v39, v75
  v_mfma_f32_16x16x32_bf16 v[36:39], a[108:111], v[32:35], 0
  s_waitcnt vmcnt(9)
  v_fmac_f32 v26, v42, v89
  v_fmac_f32 v27, v44, v76
  v_mfma_f32_16x16x32_bf16 v[188:191], v[132:135], v[108:111], v[188:191]
  v_fmac_f32 v27, v45, v77
  v_fmac_f32 v27, v46, v78
  v_mfma_f32_16x16x32_bf16 v[40:43], a[172:175], v[32:35], 0
  v_fmac_f32 v27, v47, v79
  v_fmac_f32 v27, v36, v80
  v_mfma_f32_16x16x32_bf16 v[184:187], v[132:135], v[104:107], v[184:187]
  v_fmac_f32 v27, v37, v81
  v_fmac_f32 v27, v38, v82
  v_mfma_f32_16x16x32_bf16 v[44:47], a[236:239], v[32:35], 0
  v_fmac_f32 v27, v39, v83
  v_mfma_f32_16x16x32_bf16 v[36:39], v[236:239], v[32:35], 0
  v_fmac_f32 v27, v40, v84
  v_fmac_f32 v27, v41, v85
  v_mfma_f32_16x16x32_bf16 v[180:183], v[132:135], v[100:103], v[180:183]
  v_fmac_f32 v27, v42, v86
  v_fmac_f32 v27, v43, v87
  v_mfma_f32_16x16x32_bf16 v[40:43], v[32:35], v[32:35], 0
  v_fmac_f32 v27, v44, v64
  v_fmac_f32 v27, v45, v65
  v_mfma_f32_16x16x32_bf16 v[176:179], v[132:135], v[96:99], v[176:179]
  buffer_load_dwordx4 v[132:135], v4, s[32:35], s43 offen offset:1024 sc1
  v_fmac_f32 v27, v46, v66
  v_fmac_f32 v27, v47, v67
  v_mfma_f32_16x16x32_bf16 v[44:47], v[56:59], v[32:35], 0
  s_waitcnt vmcnt(8) lgkmcnt(3)
  v_fmac_f32 v27, v36, v68
  v_fmac_f32 v27, v37, v69
  v_mfma_f32_16x16x32_bf16 v[160:163], v[136:139], v[112:115], v[160:163]
  s_waitcnt lgkmcnt(0)
  ds_read_b128 v[96:99], v5 offset:896
  ds_read_b128 v[100:103], v5 offset:17536
  v_fmac_f32 v27, v38, v70
  v_fmac_f32 v27, v39, v71
  v_mfma_f32_16x16x32_bf16 v[36:39], a[48:51], v[12:15], 0
  ds_read_b128 v[104:107], v5 offset:34176
  ds_read_b128 v[108:111], v5 offset:50816
  v_mfma_f32_16x16x32_bf16 v[164:167], v[136:139], v[116:119], v[164:167]
  ds_read_b128 v[32:35], v9 offset:13520
  v_fmac_f32 v27, v40, v72
  v_fmac_f32 v27, v41, v73
  v_fmac_f32 v27, v42, v74
  v_fmac_f32 v27, v43, v75
  v_mfma_f32_16x16x32_bf16 v[40:43], a[112:115], v[12:15], 0
  v_fmac_f32 v27, v47, v89
  v_fmac_f32 v28, v36, v76
  v_mfma_f32_16x16x32_bf16 v[168:171], v[136:139], v[120:123], v[168:171]
  v_fmac_f32 v28, v37, v77
  v_fmac_f32 v28, v38, v78
  v_mfma_f32_16x16x32_bf16 v[44:47], a[176:179], v[12:15], 0
  v_fmac_f32 v28, v39, v79
  v_mfma_f32_16x16x32_bf16 v[172:175], v[136:139], v[124:127], v[172:175]
  buffer_load_dwordx4 v[136:139], v4, s[32:35], s43 offen offset:2048 sc1
  v_fmac_f32 v28, v40, v80
  v_fmac_f32 v28, v41, v81
  v_mfma_f32_16x16x32_bf16 v[36:39], a[240:243], v[12:15], 0
  v_fmac_f32 v28, v42, v82
  v_fmac_f32 v28, v43, v83
  v_mfma_f32_16x16x32_bf16 v[40:43], v[240:243], v[12:15], 0
  s_waitcnt vmcnt(8)
  v_fmac_f32 v28, v44, v84
  v_fmac_f32 v28, v45, v85
  v_mfma_f32_16x16x32_bf16 v[188:191], v[140:143], v[124:127], v[188:191]
  v_fmac_f32 v28, v46, v86
  v_fmac_f32 v28, v47, v87
  v_mfma_f32_16x16x32_bf16 v[44:47], v[12:15], v[12:15], 0
  v_fmac_f32 v28, v36, v64
  v_fmac_f32 v28, v37, v65
  v_mfma_f32_16x16x32_bf16 v[184:187], v[140:143], v[120:123], v[184:187]
  v_fmac_f32 v28, v38, v66
  v_fmac_f32 v28, v39, v67
  v_mfma_f32_16x16x32_bf16 v[36:39], v[60:63], v[12:15], 0
  v_fmac_f32 v28, v40, v68
  v_fmac_f32 v28, v41, v69
  v_mfma_f32_16x16x32_bf16 v[180:183], v[140:143], v[116:119], v[180:183]
  s_waitcnt lgkmcnt(0)
  v_fmac_f32 v28, v42, v70
  v_fmac_f32 v28, v43, v71
  v_mfma_f32_16x16x32_bf16 v[40:43], a[52:55], v[32:35], 0
  ds_read_b128 v[12:15], v9 offset:14560
  v_fmac_f32 v28, v44, v72
  v_mfma_f32_16x16x32_bf16 v[176:179], v[140:143], v[112:115], v[176:179]
  buffer_load_dwordx4 v[140:143], v4, s[32:35], s43 offen offset:3072 sc1
  v_fmac_f32 v28, v45, v73
  v_fmac_f32 v28, v46, v74
  v_fmac_f32 v28, v47, v75
  v_mfma_f32_16x16x32_bf16 v[44:47], a[116:119], v[32:35], 0
  s_waitcnt vmcnt(7)
  v_fmac_f32 v28, v36, v89
  v_fmac_f32 v29, v40, v76
  v_mfma_f32_16x16x32_bf16 v[160:163], v[144:147], v[96:99], v[160:163]
  s_add_u32 s43, s43, 8192
  ds_read_b128 v[112:115], v5 offset:960
  ds_read_b128 v[116:119], v5 offset:17600
  v_mfma_f32_16x16x32_bf16 v[36:39], a[180:183], v[32:35], 0
  ds_read_b128 v[120:123], v5 offset:34240
  ds_read_b128 v[124:127], v5 offset:50880
  v_mfma_f32_16x16x32_bf16 v[164:167], v[144:147], v[100:103], v[164:167]
  v_fmac_f32 v29, v41, v77
  v_fmac_f32 v29, v42, v78
  v_fmac_f32 v29, v43, v79
  v_mfma_f32_16x16x32_bf16 v[40:43], a[244:247], v[32:35], 0
  v_fmac_f32 v29, v44, v80
  v_fmac_f32 v29, v45, v81
  v_fmac_f32 v29, v46, v82
  v_fmac_f32 v29, v47, v83
  v_mfma_f32_16x16x32_bf16 v[44:47], v[244:247], v[32:35], 0
  v_fmac_f32 v29, v36, v84
  v_fmac_f32 v29, v37, v85
  v_mfma_f32_16x16x32_bf16 v[168:171], v[144:147], v[104:107], v[168:171]
  v_fmac_f32 v29, v38, v86
  v_fmac_f32 v29, v39, v87
  v_mfma_f32_16x16x32_bf16 v[36:39], v[32:35], v[32:35], 0
  v_fmac_f32 v29, v40, v64
  v_fmac_f32 v29, v41, v65
  v_mfma_f32_16x16x32_bf16 v[172:175], v[144:147], v[108:111], v[172:175]
  buffer_load_dwordx4 v[144:147], v4, s[32:35], s62 offen offset:0 sc1
  v_fmac_f32 v29, v42, v66
  v_fmac_f32 v29, v43, v67
  v_mfma_f32_16x16x32_bf16 v[40:43], v[60:63], v[32:35], 0
  s_waitcnt vmcnt(7)
  v_fmac_f32 v29, v44, v68
  v_fmac_f32 v29, v45, v69
  v_mfma_f32_16x16x32_bf16 v[188:191], v[148:151], v[108:111], v[188:191]
  s_waitcnt lgkmcnt(4)
  v_add_u32 v11, 66560, v11
  v_xad_u32 v5, v7, 0, v11
  v_fmac_f32 v29, v46, v70
  v_fmac_f32 v29, v47, v71
  v_mfma_f32_16x16x32_bf16 v[44:47], a[56:59], v[12:15], 0
  ds_read_b128 v[32:35], v9 offset:15600
  v_fmac_f32 v29, v36, v72
  v_mfma_f32_16x16x32_bf16 v[184:187], v[148:151], v[104:107], v[184:187]
  v_fmac_f32 v29, v37, v73
  v_fmac_f32 v29, v38, v74
  v_fmac_f32 v29, v39, v75
  v_mfma_f32_16x16x32_bf16 v[36:39], a[120:123], v[12:15], 0
  v_fmac_f32 v29, v41, v89
  v_fmac_f32 v30, v44, v76
  v_mfma_f32_16x16x32_bf16 v[180:183], v[148:151], v[100:103], v[180:183]
  v_fmac_f32 v30, v45, v77
  v_fmac_f32 v30, v46, v78
  v_mfma_f32_16x16x32_bf16 v[40:43], a[184:187], v[12:15], 0
  v_fmac_f32 v30, v47, v79
  v_mfma_f32_16x16x32_bf16 v[176:179], v[148:151], v[96:99], v[176:179]
  buffer_load_dwordx4 v[148:151], v4, s[32:35], s62 offen offset:1024 sc1
  v_fmac_f32 v30, v36, v80
  v_fmac_f32 v30, v37, v81
  v_mfma_f32_16x16x32_bf16 v[44:47], a[248:251], v[12:15], 0
  v_fmac_f32 v30, v38, v82
  v_fmac_f32 v30, v39, v83
  v_mfma_f32_16x16x32_bf16 v[36:39], v[248:251], v[12:15], 0
  s_waitcnt vmcnt(7) lgkmcnt(1)
  s_barrier
  v_fmac_f32 v30, v40, v84
  v_fmac_f32 v30, v41, v85
  v_mfma_f32_16x16x32_bf16 v[160:163], v[152:155], v[112:115], v[160:163]
  ds_read_b128 v[96:99], v5 offset:0
  ds_read_b128 v[100:103], v5 offset:16640
  v_fmac_f32 v30, v42, v86
  v_fmac_f32 v30, v43, v87
  v_mfma_f32_16x16x32_bf16 v[40:43], v[12:15], v[12:15], 0
  ds_read_b128 v[104:107], v5 offset:33280
  ds_read_b128 v[108:111], v5 offset:49920
  v_mfma_f32_16x16x32_bf16 v[164:167], v[152:155], v[116:119], v[164:167]
  v_fmac_f32 v30, v44, v64
  v_fmac_f32 v30, v45, v65
  v_fmac_f32 v30, v46, v66
  v_fmac_f32 v30, v47, v67
  v_mfma_f32_16x16x32_bf16 v[44:47], v[60:63], v[12:15], 0
  v_fmac_f32 v30, v36, v68
  v_fmac_f32 v30, v37, v69
  v_mfma_f32_16x16x32_bf16 v[168:171], v[152:155], v[120:123], v[168:171]
  s_waitcnt lgkmcnt(4)
  v_fmac_f32 v30, v38, v70
  v_fmac_f32 v30, v39, v71
  v_mfma_f32_16x16x32_bf16 v[36:39], a[60:63], v[32:35], 0
  v_fmac_f32 v30, v40, v72
  v_fmac_f32 v30, v41, v73
  v_mfma_f32_16x16x32_bf16 v[172:175], v[152:155], v[124:127], v[172:175]
  buffer_load_dwordx4 v[152:155], v4, s[32:35], s62 offen offset:2048 sc1
  v_fmac_f32 v30, v42, v74
  v_fmac_f32 v30, v43, v75
  v_mfma_f32_16x16x32_bf16 v[40:43], a[124:127], v[32:35], 0
  s_waitcnt vmcnt(7)
  v_fmac_f32 v30, v46, v89
  v_fmac_f32 v31, v36, v76
  v_mfma_f32_16x16x32_bf16 v[188:191], v[156:159], v[124:127], v[188:191]
  v_fmac_f32 v31, v37, v77
  v_fmac_f32 v31, v38, v78
  v_mfma_f32_16x16x32_bf16 v[44:47], a[188:191], v[32:35], 0
  v_fmac_f32 v31, v39, v79
  v_fmac_f32 v31, v40, v80
  v_mfma_f32_16x16x32_bf16 v[184:187], v[156:159], v[120:123], v[184:187]
  v_fmac_f32 v31, v41, v81
  v_fmac_f32 v31, v42, v82
  v_mfma_f32_16x16x32_bf16 v[180:183], v[156:159], v[116:119], v[180:183]
  v_fmac_f32 v31, v43, v83
  v_mfma_f32_16x16x32_bf16 v[36:39], a[252:255], v[32:35], 0
  v_fmac_f32 v31, v44, v84
  v_fmac_f32 v31, v45, v85
  v_mfma_f32_16x16x32_bf16 v[176:179], v[156:159], v[112:115], v[176:179]
  buffer_load_dwordx4 v[156:159], v4, s[32:35], s62 offen offset:3072 sc1
  v_fmac_f32 v31, v46, v86
  v_fmac_f32 v31, v47, v87
  v_mfma_f32_16x16x32_bf16 v[40:43], v[252:255], v[32:35], 0
  s_waitcnt vmcnt(7) lgkmcnt(2)
  v_fmac_f32 v31, v36, v64
  v_fmac_f32 v31, v37, v65
  v_mfma_f32_16x16x32_bf16 v[160:163], v[128:131], v[96:99], v[160:163]
  s_add_u32 s62, s62, 8192
  ds_read_b128 v[112:115], v5 offset:64
  ds_read_b128 v[116:119], v5 offset:16704
  v_mfma_f32_16x16x32_bf16 v[44:47], v[32:35], v[32:35], 0
  ds_read_b128 v[120:123], v5 offset:33344
  ds_read_b128 v[124:127], v5 offset:49984
  v_mfma_f32_16x16x32_bf16 v[164:167], v[128:131], v[100:103], v[164:167]
  v_fmac_f32 v31, v38, v66
  v_fmac_f32 v31, v39, v67
  v_mfma_f32_16x16x32_bf16 v[36:39], v[60:63], v[32:35], 0
  s_waitcnt lgkmcnt(4)
  v_fmac_f32 v31, v40, v68
  v_fmac_f32 v31, v41, v69
  v_mfma_f32_16x16x32_bf16 v[168:171], v[128:131], v[104:107], v[168:171]
  v_fmac_f32 v31, v42, v70
  v_fmac_f32 v31, v43, v71
  v_mfma_f32_16x16x32_bf16 v[172:175], v[128:131], v[108:111], v[172:175]
  s_waitcnt vmcnt(6)
  buffer_load_dwordx4 v[128:131], v4, s[32:35], s43 offen offset:0 sc1
  v_fmac_f32 v31, v44, v72
  v_fmac_f32 v31, v45, v73
  v_mfma_f32_16x16x32_bf16 v[188:191], v[132:135], v[108:111], v[188:191]
  v_fmac_f32 v31, v46, v74
  v_fmac_f32 v31, v47, v75
  v_mfma_f32_16x16x32_bf16 v[184:187], v[132:135], v[104:107], v[184:187]
  v_fmac_f32 v31, v39, v89
  v_mfma_f32_16x16x32_bf16 v[180:183], v[132:135], v[100:103], v[180:183]
  v_permlane32_swap_b32 v16, v24
  v_permlane32_swap_b32 v17, v25
  v_mfma_f32_16x16x32_bf16 v[176:179], v[132:135], v[96:99], v[176:179]
  s_waitcnt vmcnt(6) lgkmcnt(2)
  buffer_load_dwordx4 v[132:135], v4, s[32:35], s43 offen offset:1024 sc1
  v_permlane32_swap_b32 v18, v26
  v_permlane32_swap_b32 v19, v27
  v_mfma_f32_16x16x32_bf16 v[160:163], v[136:139], v[112:115], v[160:163]
  ds_read_b128 v[96:99], v5 offset:128
  ds_read_b128 v[100:103], v5 offset:16768
  v_mfma_f32_16x16x32_bf16 v[164:167], v[136:139], v[116:119], v[164:167]
  s_waitcnt lgkmcnt(2)
  ds_read_b128 v[104:107], v5 offset:33408
  ds_read_b128 v[108:111], v5 offset:50048
  v_mfma_f32_16x16x32_bf16 v[168:171], v[136:139], v[120:123], v[168:171]
  v_permlane32_swap_b32 v20, v28
  v_permlane32_swap_b32 v21, v29
  v_mfma_f32_16x16x32_bf16 v[172:175], v[136:139], v[124:127], v[172:175]
  s_waitcnt vmcnt(6)
  buffer_load_dwordx4 v[136:139], v4, s[32:35], s43 offen offset:2048 sc1
  v_permlane32_swap_b32 v22, v30
  v_permlane32_swap_b32 v23, v31
  v_mfma_f32_16x16x32_bf16 v[188:191], v[140:143], v[124:127], v[188:191]
  v_add_f32 v16, v16, v24
  v_add_f32 v17, v17, v25
  v_mfma_f32_16x16x32_bf16 v[184:187], v[140:143], v[120:123], v[184:187]
  v_add_f32 v18, v18, v26
  v_add_f32 v19, v19, v27
  v_mfma_f32_16x16x32_bf16 v[180:183], v[140:143], v[116:119], v[180:183]
  v_add_f32 v20, v20, v28
  v_add_f32 v21, v21, v29
  v_mfma_f32_16x16x32_bf16 v[176:179], v[140:143], v[112:115], v[176:179]
  s_waitcnt vmcnt(6) lgkmcnt(2)
  buffer_load_dwordx4 v[140:143], v4, s[32:35], s43 offen offset:3072 sc1
  v_add_f32 v22, v22, v30
  v_add_f32 v23, v23, v31
  v_mfma_f32_16x16x32_bf16 v[160:163], v[144:147], v[96:99], v[160:163]
  s_add_u32 s43, s43, 8192
  ds_read_b128 v[112:115], v5 offset:192
  ds_read_b128 v[116:119], v5 offset:16832
  v_mfma_f32_16x16x32_bf16 v[164:167], v[144:147], v[100:103], v[164:167]
  s_waitcnt lgkmcnt(2)
  ds_read_b128 v[120:123], v5 offset:33472
  ds_read_b128 v[124:127], v5 offset:50112
  v_mfma_f32_16x16x32_bf16 v[168:171], v[144:147], v[104:107], v[168:171]
  v_permlane16_swap_b32 v16, v20
  v_permlane16_swap_b32 v17, v21
  v_mfma_f32_16x16x32_bf16 v[172:175], v[144:147], v[108:111], v[172:175]
  s_waitcnt vmcnt(6)
  buffer_load_dwordx4 v[144:147], v4, s[32:35], s62 offen offset:0 sc1
  v_permlane16_swap_b32 v18, v22
  v_permlane16_swap_b32 v19, v23
  v_mfma_f32_16x16x32_bf16 v[188:191], v[148:151], v[108:111], v[188:191]
  v_xad_u32 v5, v7, 48, v11
  v_add_f32 v16, v16, v20
  v_mfma_f32_16x16x32_bf16 v[184:187], v[148:151], v[104:107], v[184:187]
  v_add_f32 v17, v17, v21
  v_add_f32 v18, v18, v22
  v_mfma_f32_16x16x32_bf16 v[180:183], v[148:151], v[100:103], v[180:183]
  v_add_f32 v19, v19, v23
  v_add_f32_dpp v20, v16, v16 row_ror:8 row_mask:0xf bank_mask:0xf
  v_mfma_f32_16x16x32_bf16 v[176:179], v[148:151], v[96:99], v[176:179]
  s_waitcnt vmcnt(6) lgkmcnt(2)
  buffer_load_dwordx4 v[148:151], v4, s[32:35], s62 offen offset:1024 sc1
  v_add_f32_dpp v21, v17, v17 row_ror:8 row_mask:0xf bank_mask:0xf
  v_add_f32_dpp v20, v18, v18 row_ror:8 row_mask:0xf bank_mask:0xc
  v_mfma_f32_16x16x32_bf16 v[160:163], v[152:155], v[112:115], v[160:163]
  ds_read_b128 v[96:99], v5 offset:256
  ds_read_b128 v[100:103], v5 offset:16896
  v_mfma_f32_16x16x32_bf16 v[164:167], v[152:155], v[116:119], v[164:167]
  s_waitcnt lgkmcnt(2)
  ds_read_b128 v[104:107], v5 offset:33536
  ds_read_b128 v[108:111], v5 offset:50176
  v_mfma_f32_16x16x32_bf16 v[168:171], v[152:155], v[120:123], v[168:171]
  v_add_f32_dpp v21, v19, v19 row_ror:8 row_mask:0xf bank_mask:0xc
  v_add_f32_dpp v16, v20, v20 row_half_mirror row_mask:0xf bank_mask:0xf
  v_mfma_f32_16x16x32_bf16 v[172:175], v[152:155], v[124:127], v[172:175]
  s_waitcnt vmcnt(6)
  buffer_load_dwordx4 v[152:155], v4, s[32:35], s62 offen offset:2048 sc1
  v_and_b32 v3, 60, v0
  v_add_f32_dpp v16, v21, v21 row_half_mirror row_mask:0xf bank_mask:0xa
  v_mfma_f32_16x16x32_bf16 v[188:191], v[156:159], v[124:127], v[188:191]
  s_lshl_b32 s45, s40, 6
  s_add_u32 s45, s45, 163072
  v_mfma_f32_16x16x32_bf16 v[184:187], v[156:159], v[120:123], v[184:187]
  v_add_f32_dpp v16, v16, v16 quad_perm:[1,0,3,2] row_mask:0xf bank_mask:0xf
  v_add_u32 v3, s45, v3
  v_mfma_f32_16x16x32_bf16 v[180:183], v[156:159], v[116:119], v[180:183]
  s_add_u32 s45, s75, 161792
  v_lshrrev_b32 v2, 4, v0
  v_mfma_f32_16x16x32_bf16 v[176:179], v[156:159], v[112:115], v[176:179]
  s_waitcnt vmcnt(6) lgkmcnt(2)
  buffer_load_dwordx4 v[156:159], v4, s[32:35], s62 offen offset:3072 sc1
  v_lshl_add_u32 v2, v2, 5, s45
  v_add_f32_dpp v16, v16, v16 quad_perm:[2,3,0,1] row_mask:0xf bank_mask:0xf
  v_mfma_f32_16x16x32_bf16 v[160:163], v[128:131], v[96:99], v[160:163]
  s_add_u32 s62, s62, 8192
  ds_read_b128 v[112:115], v5 offset:320
  ds_read_b128 v[116:119], v5 offset:16960
  v_mfma_f32_16x16x32_bf16 v[164:167], v[128:131], v[100:103], v[164:167]
  s_waitcnt lgkmcnt(2)
  ds_read_b128 v[120:123], v5 offset:33600
  ds_read_b128 v[124:127], v5 offset:50240
  v_mfma_f32_16x16x32_bf16 v[168:171], v[128:131], v[104:107], v[168:171]
  ds_write_b32 v3, v16
  ds_read_b32 v64, v2 offset:0
  v_mfma_f32_16x16x32_bf16 v[172:175], v[128:131], v[108:111], v[172:175]
  s_waitcnt vmcnt(6)
  buffer_load_dwordx4 v[128:131], v4, s[32:35], s43 offen offset:0 sc1
  ds_read_b32 v65, v2 offset:8
  ds_read_b32 v66, v2 offset:16
  v_mfma_f32_16x16x32_bf16 v[188:191], v[132:135], v[108:111], v[188:191]
  ds_read_b32 v67, v2 offset:24
  s_mov_b32 s60, 0xbdd2d3e8
  v_mfma_f32_16x16x32_bf16 v[184:187], v[132:135], v[104:107], v[184:187]
  s_mov_b32 s61, 0xbdd2d3e8
  v_mov_b32 v36, 0xc0135761
  v_mfma_f32_16x16x32_bf16 v[180:183], v[132:135], v[100:103], v[180:183]
  v_mov_b32 v37, 0xc0135761
  v_mov_b32 v38, 1.0
  v_mfma_f32_16x16x32_bf16 v[176:179], v[132:135], v[96:99], v[176:179]
  s_waitcnt vmcnt(6) lgkmcnt(7)
  buffer_load_dwordx4 v[132:135], v4, s[32:35], s43 offen offset:1024 sc1
  v_mov_b32 v39, 1.0
  s_mov_b32 s36, s18
  v_mfma_f32_16x16x32_bf16 v[160:163], v[136:139], v[112:115], v[160:163]
  ds_read_b128 v[96:99], v5 offset:384
  ds_read_b128 v[100:103], v5 offset:17024
  v_mfma_f32_16x16x32_bf16 v[164:167], v[136:139], v[116:119], v[164:167]
  s_waitcnt lgkmcnt(7)
  ds_read_b128 v[104:107], v5 offset:33664
  ds_read_b128 v[108:111], v5 offset:50304
  v_mfma_f32_16x16x32_bf16 v[168:171], v[136:139], v[120:123], v[168:171]
  s_and_b32 s37, s19, 0xffff
  s_mov_b32 s38, 32768
  v_mfma_f32_16x16x32_bf16 v[172:175], v[136:139], v[124:127], v[172:175]
  s_waitcnt vmcnt(6)
  buffer_load_dwordx4 v[136:139], v4, s[32:35], s43 offen offset:2048 sc1
  s_mov_b32 s39, 0x00020000
  s_waitcnt lgkmcnt(4)
  v_mfma_f32_16x16x32_bf16 v[188:191], v[140:143], v[124:127], v[188:191]
  v_lshlrev_b32 v68, 16, v64
  v_and_b32 v72, 0xffff0000, v64
  v_mfma_f32_16x16x32_bf16 v[184:187], v[140:143], v[120:123], v[184:187]
  v_lshlrev_b32 v69, 16, v65
  v_and_b32 v73, 0xffff0000, v65
  v_mfma_f32_16x16x32_bf16 v[180:183], v[140:143], v[116:119], v[180:183]
  v_lshlrev_b32 v70, 16, v66
  v_and_b32 v74, 0xffff0000, v66
  v_mfma_f32_16x16x32_bf16 v[176:179], v[140:143], v[112:115], v[176:179]
  s_waitcnt vmcnt(6) lgkmcnt(2)
  buffer_load_dwordx4 v[140:143], v4, s[32:35], s43 offen offset:3072 sc1
  v_lshlrev_b32 v71, 16, v67
  v_and_b32 v75, 0xffff0000, v67
  v_mfma_f32_16x16x32_bf16 v[160:163], v[144:147], v[96:99], v[160:163]
  s_add_u32 s43, s43, 8192
  ds_read_b128 v[112:115], v5 offset:448
  ds_read_b128 v[116:119], v5 offset:17088
  v_mfma_f32_16x16x32_bf16 v[164:167], v[144:147], v[100:103], v[164:167]
  s_waitcnt lgkmcnt(2)
  ds_read_b128 v[120:123], v5 offset:33728
  ds_read_b128 v[124:127], v5 offset:50368
  v_mfma_f32_16x16x32_bf16 v[168:171], v[144:147], v[104:107], v[168:171]
  v_mfma_f32_16x16x32_bf16 v[172:175], v[144:147], v[108:111], v[172:175]
  s_waitcnt vmcnt(6)
  buffer_load_dwordx4 v[144:147], v4, s[32:35], s62 offen offset:0 sc1
  v_mfma_f32_16x16x32_bf16 v[188:191], v[148:151], v[108:111], v[188:191]
  v_xad_u32 v5, v7, 32, v11
  v_mfma_f32_16x16x32_bf16 v[184:187], v[148:151], v[104:107], v[184:187]
  v_mfma_f32_16x16x32_bf16 v[180:183], v[148:151], v[100:103], v[180:183]
  v_mfma_f32_16x16x32_bf16 v[176:179], v[148:151], v[96:99], v[176:179]
  s_waitcnt vmcnt(6) lgkmcnt(2)
  buffer_load_dwordx4 v[148:151], v4, s[32:35], s62 offen offset:1024 sc1
  v_mfma_f32_16x16x32_bf16 v[160:163], v[152:155], v[112:115], v[160:163]
  ds_read_b128 v[96:99], v5 offset:512
  ds_read_b128 v[100:103], v5 offset:17152
  v_mfma_f32_16x16x32_bf16 v[164:167], v[152:155], v[116:119], v[164:167]
  s_waitcnt lgkmcnt(2)
  ds_read_b128 v[104:107], v5 offset:33792
  ds_read_b128 v[108:111], v5 offset:50432
  v_mfma_f32_16x16x32_bf16 v[168:171], v[152:155], v[120:123], v[168:171]
  v_mfma_f32_16x16x32_bf16 v[172:175], v[152:155], v[124:127], v[172:175]
  s_waitcnt vmcnt(6)
  buffer_load_dwordx4 v[152:155], v4, s[32:35], s62 offen offset:2048 sc1
  v_mfma_f32_16x16x32_bf16 v[188:191], v[156:159], v[124:127], v[188:191]
  v_mfma_f32_16x16x32_bf16 v[184:187], v[156:159], v[120:123], v[184:187]
  v_mfma_f32_16x16x32_bf16 v[180:183], v[156:159], v[116:119], v[180:183]
  v_mfma_f32_16x16x32_bf16 v[176:179], v[156:159], v[112:115], v[176:179]
  s_waitcnt vmcnt(6) lgkmcnt(2)
  buffer_load_dwordx4 v[156:159], v4, s[32:35], s62 offen offset:3072 sc1
  v_mfma_f32_16x16x32_bf16 v[160:163], v[128:131], v[96:99], v[160:163]
  s_add_u32 s62, s62, 8192
  ds_read_b128 v[112:115], v5 offset:576
  ds_read_b128 v[116:119], v5 offset:17216
  v_mfma_f32_16x16x32_bf16 v[164:167], v[128:131], v[100:103], v[164:167]
  s_waitcnt lgkmcnt(2)
  ds_read_b128 v[120:123], v5 offset:33856
  ds_read_b128 v[124:127], v5 offset:50496
  v_mfma_f32_16x16x32_bf16 v[168:171], v[128:131], v[104:107], v[168:171]
  v_mfma_f32_16x16x32_bf16 v[172:175], v[128:131], v[108:111], v[172:175]
  s_waitcnt vmcnt(6)
  buffer_load_dwordx4 v[128:131], v4, s[32:35], s43 offen offset:0 sc1
  v_mfma_f32_16x16x32_bf16 v[188:191], v[132:135], v[108:111], v[188:191]
  v_mfma_f32_16x16x32_bf16 v[184:187], v[132:135], v[104:107], v[184:187]
  v_mfma_f32_16x16x32_bf16 v[180:183], v[132:135], v[100:103], v[180:183]
  v_mfma_f32_16x16x32_bf16 v[176:179], v[132:135], v[96:99], v[176:179]
  s_waitcnt vmcnt(6) lgkmcnt(2)
  buffer_load_dwordx4 v[132:135], v4, s[32:35], s43 offen offset:1024 sc1
  v_mfma_f32_16x16x32_bf16 v[160:163], v[136:139], v[112:115], v[160:163]
  ds_read_b128 v[96:99], v5 offset:640
  ds_read_b128 v[100:103], v5 offset:17280
  v_mfma_f32_16x16x32_bf16 v[164:167], v[136:139], v[116:119], v[164:167]
  s_waitcnt lgkmcnt(2)
  ds_read_b128 v[104:107], v5 offset:33920
  ds_read_b128 v[108:111], v5 offset:50560
  v_mfma_f32_16x16x32_bf16 v[168:171], v[136:139], v[120:123], v[168:171]
  v_mfma_f32_16x16x32_bf16 v[172:175], v[136:139], v[124:127], v[172:175]
  s_waitcnt vmcnt(6)
  buffer_load_dwordx4 v[136:139], v4, s[32:35], s43 offen offset:2048 sc1
  v_mfma_f32_16x16x32_bf16 v[188:191], v[140:143], v[124:127], v[188:191]
  v_mfma_f32_16x16x32_bf16 v[184:187], v[140:143], v[120:123], v[184:187]
  v_mfma_f32_16x16x32_bf16 v[180:183], v[140:143], v[116:119], v[180:183]
  v_mfma_f32_16x16x32_bf16 v[176:179], v[140:143], v[112:115], v[176:179]
  s_waitcnt vmcnt(6) lgkmcnt(2)
  buffer_load_dwordx4 v[140:143], v4, s[32:35], s43 offen offset:3072 sc1
  v_mfma_f32_16x16x32_bf16 v[160:163], v[144:147], v[96:99], v[160:163]
  s_add_u32 s43, s43, 8192
  ds_read_b128 v[112:115], v5 offset:704
  ds_read_b128 v[116:119], v5 offset:17344
  v_mfma_f32_16x16x32_bf16 v[164:167], v[144:147], v[100:103], v[164:167]
  s_waitcnt lgkmcnt(2)
  ds_read_b128 v[120:123], v5 offset:33984
  ds_read_b128 v[124:127], v5 offset:50624
  v_mfma_f32_16x16x32_bf16 v[168:171], v[144:147], v[104:107], v[168:171]
  v_mfma_f32_16x16x32_bf16 v[172:175], v[144:147], v[108:111], v[172:175]
  s_waitcnt vmcnt(6)
  buffer_load_dwordx4 v[144:147], v4, s[32:35], s62 offen offset:0 sc1
  v_mfma_f32_16x16x32_bf16 v[188:191], v[148:151], v[108:111], v[188:191]
  v_xad_u32 v5, v7, 16, v11
  v_mfma_f32_16x16x32_bf16 v[184:187], v[148:151], v[104:107], v[184:187]
  v_mfma_f32_16x16x32_bf16 v[180:183], v[148:151], v[100:103], v[180:183]
  v_mfma_f32_16x16x32_bf16 v[176:179], v[148:151], v[96:99], v[176:179]
  s_waitcnt vmcnt(6) lgkmcnt(2)
  buffer_load_dwordx4 v[148:151], v4, s[32:35], s62 offen offset:1024 sc1
  v_mfma_f32_16x16x32_bf16 v[160:163], v[152:155], v[112:115], v[160:163]
  ds_read_b128 v[96:99], v5 offset:768
  ds_read_b128 v[100:103], v5 offset:17408
  v_mfma_f32_16x16x32_bf16 v[164:167], v[152:155], v[116:119], v[164:167]
  s_waitcnt lgkmcnt(2)
  ds_read_b128 v[104:107], v5 offset:34048
  ds_read_b128 v[108:111], v5 offset:50688
  v_mfma_f32_16x16x32_bf16 v[168:171], v[152:155], v[120:123], v[168:171]
  v_mfma_f32_16x16x32_bf16 v[172:175], v[152:155], v[124:127], v[172:175]
  s_waitcnt vmcnt(6)
  buffer_load_dwordx4 v[152:155], v4, s[32:35], s62 offen offset:2048 sc1
  v_mfma_f32_16x16x32_bf16 v[188:191], v[156:159], v[124:127], v[188:191]
  v_mfma_f32_16x16x32_bf16 v[184:187], v[156:159], v[120:123], v[184:187]
  v_mfma_f32_16x16x32_bf16 v[180:183], v[156:159], v[116:119], v[180:183]
  v_mfma_f32_16x16x32_bf16 v[176:179], v[156:159], v[112:115], v[176:179]
  s_waitcnt vmcnt(6) lgkmcnt(2)
  buffer_load_dwordx4 v[156:159], v4, s[32:35], s62 offen offset:3072 sc1
  v_mfma_f32_16x16x32_bf16 v[160:163], v[128:131], v[96:99], v[160:163]
  s_add_u32 s62, s62, 8192
  ds_read_b128 v[112:115], v5 offset:832
  ds_read_b128 v[116:119], v5 offset:17472
  v_mfma_f32_16x16x32_bf16 v[164:167], v[128:131], v[100:103], v[164:167]
  s_waitcnt lgkmcnt(2)
  ds_read_b128 v[120:123], v5 offset:34112
  ds_read_b128 v[124:127], v5 offset:50752
  v_mfma_f32_16x16x32_bf16 v[168:171], v[128:131], v[104:107], v[168:171]
  v_mfma_f32_16x16x32_bf16 v[172:175], v[128:131], v[108:111], v[172:175]
  s_waitcnt vmcnt(6)
  v_mfma_f32_16x16x32_bf16 v[188:191], v[132:135], v[108:111], v[188:191]
  v_mfma_f32_16x16x32_bf16 v[184:187], v[132:135], v[104:107], v[184:187]
  v_mfma_f32_16x16x32_bf16 v[180:183], v[132:135], v[100:103], v[180:183]
  v_mfma_f32_16x16x32_bf16 v[176:179], v[132:135], v[96:99], v[176:179]
  s_waitcnt vmcnt(5) lgkmcnt(2)
  v_mfma_f32_16x16x32_bf16 v[160:163], v[136:139], v[112:115], v[160:163]
  ds_read_b128 v[96:99], v5 offset:896
  ds_read_b128 v[100:103], v5 offset:17536
  v_mfma_f32_16x16x32_bf16 v[164:167], v[136:139], v[116:119], v[164:167]
  s_waitcnt lgkmcnt(2)
  ds_read_b128 v[104:107], v5 offset:34176
  ds_read_b128 v[108:111], v5 offset:50816
  v_mfma_f32_16x16x32_bf16 v[168:171], v[136:139], v[120:123], v[168:171]
  v_mfma_f32_16x16x32_bf16 v[172:175], v[136:139], v[124:127], v[172:175]
  s_waitcnt vmcnt(4)
  v_mfma_f32_16x16x32_bf16 v[188:191], v[140:143], v[124:127], v[188:191]
  v_mfma_f32_16x16x32_bf16 v[184:187], v[140:143], v[120:123], v[184:187]
  v_mfma_f32_16x16x32_bf16 v[180:183], v[140:143], v[116:119], v[180:183]
  v_mfma_f32_16x16x32_bf16 v[176:179], v[140:143], v[112:115], v[176:179]
  s_waitcnt vmcnt(3) lgkmcnt(2)
  v_mfma_f32_16x16x32_bf16 v[160:163], v[144:147], v[96:99], v[160:163]
  ds_read_b128 v[112:115], v5 offset:960
  ds_read_b128 v[116:119], v5 offset:17600
  v_mfma_f32_16x16x32_bf16 v[164:167], v[144:147], v[100:103], v[164:167]
  s_waitcnt lgkmcnt(2)
  ds_read_b128 v[120:123], v5 offset:34240
  ds_read_b128 v[124:127], v5 offset:50880
  v_mfma_f32_16x16x32_bf16 v[168:171], v[144:147], v[104:107], v[168:171]
  v_mfma_f32_16x16x32_bf16 v[172:175], v[144:147], v[108:111], v[172:175]
  s_waitcnt vmcnt(2)
  v_mfma_f32_16x16x32_bf16 v[188:191], v[148:151], v[108:111], v[188:191]
  v_mfma_f32_16x16x32_bf16 v[184:187], v[148:151], v[104:107], v[184:187]
  v_mfma_f32_16x16x32_bf16 v[180:183], v[148:151], v[100:103], v[180:183]
  v_mfma_f32_16x16x32_bf16 v[176:179], v[148:151], v[96:99], v[176:179]
  s_waitcnt vmcnt(1) lgkmcnt(2)
  v_mfma_f32_16x16x32_bf16 v[160:163], v[152:155], v[112:115], v[160:163]
  v_mfma_f32_16x16x32_bf16 v[164:167], v[152:155], v[116:119], v[164:167]
  s_waitcnt lgkmcnt(0)
  v_mfma_f32_16x16x32_bf16 v[168:171], v[152:155], v[120:123], v[168:171]
  v_mfma_f32_16x16x32_bf16 v[172:175], v[152:155], v[124:127], v[172:175]
  s_waitcnt vmcnt(0)
  v_mfma_f32_16x16x32_bf16 v[188:191], v[156:159], v[124:127], v[188:191]
  v_mfma_f32_16x16x32_bf16 v[184:187], v[156:159], v[120:123], v[184:187]
  v_mfma_f32_16x16x32_bf16 v[180:183], v[156:159], v[116:119], v[180:183]
  v_mfma_f32_16x16x32_bf16 v[176:179], v[156:159], v[112:115], v[176:179]
  v_pk_mul_f32 v[96:97], v[160:161], v[160:161]
  v_pk_mul_f32 v[98:99], v[164:165], v[164:165]
  v_pk_mul_f32 v[100:101], v[168:169], v[168:169]
  v_pk_mul_f32 v[102:103], v[172:173], v[172:173]
  v_pk_fma_f32 v[96:97], v[96:97], s[60:61], v[36:37]
  v_pk_fma_f32 v[98:99], v[98:99], s[60:61], v[36:37]
  v_pk_fma_f32 v[100:101], v[100:101], s[60:61], v[36:37]
  v_pk_fma_f32 v[102:103], v[102:103], s[60:61], v[36:37]
  v_pk_mul_f32 v[96:97], v[96:97], v[160:161]
  v_pk_mul_f32 v[98:99], v[98:99], v[164:165]
  v_pk_mul_f32 v[100:101], v[100:101], v[168:169]
  v_pk_mul_f32 v[102:103], v[102:103], v[172:173]
  v_exp_f32 v96, v96
  v_exp_f32 v97, v97
  v_exp_f32 v98, v98
  v_exp_f32 v99, v99
  v_exp_f32 v100, v100
  v_exp_f32 v101, v101
  v_exp_f32 v102, v102
  v_exp_f32 v103, v103
  v_pk_mul_f32 v[160:161], v[160:161], v[68:69]
  v_pk_mul_f32 v[164:165], v[164:165], v[68:69]
  v_pk_mul_f32 v[168:169], v[168:169], v[68:69]
  v_pk_mul_f32 v[172:173], v[172:173], v[68:69]
  v_pk_add_f32 v[96:97], v[96:97], v[38:39]
  v_pk_add_f32 v[98:99], v[98:99], v[38:39]
  v_pk_add_f32 v[100:101], v[100:101], v[38:39]
  v_pk_add_f32 v[102:103], v[102:103], v[38:39]
  v_rcp_f32 v96, v96
  v_rcp_f32 v97, v97
  v_rcp_f32 v98, v98
  v_rcp_f32 v99, v99
  v_rcp_f32 v100, v100
  v_rcp_f32 v101, v101
  v_rcp_f32 v102, v102
  v_rcp_f32 v103, v103
  v_pk_mul_f32 v[104:105], v[160:161], v[96:97]
  v_pk_mul_f32 v[106:107], v[164:165], v[98:99]
  v_pk_mul_f32 v[108:109], v[168:169], v[100:101]
  v_pk_mul_f32 v[110:111], v[172:173], v[102:103]
  v_pk_mul_f32 v[96:97], v[162:163], v[162:163]
  v_pk_mul_f32 v[98:99], v[166:167], v[166:167]
  v_pk_mul_f32 v[100:101], v[170:171], v[170:171]
  v_pk_mul_f32 v[102:103], v[174:175], v[174:175]
  v_pk_fma_f32 v[96:97], v[96:97], s[60:61], v[36:37]
  v_pk_fma_f32 v[98:99], v[98:99], s[60:61], v[36:37]
  v_pk_fma_f32 v[100:101], v[100:101], s[60:61], v[36:37]
  v_pk_fma_f32 v[102:103], v[102:103], s[60:61], v[36:37]
  v_pk_mul_f32 v[96:97], v[96:97], v[162:163]
  v_pk_mul_f32 v[98:99], v[98:99], v[166:167]
  v_pk_mul_f32 v[100:101], v[100:101], v[170:171]
  v_pk_mul_f32 v[102:103], v[102:103], v[174:175]
  v_exp_f32 v96, v96
  v_exp_f32 v97, v97
  v_exp_f32 v98, v98
  v_exp_f32 v99, v99
  v_exp_f32 v100, v100
  v_exp_f32 v101, v101
  v_exp_f32 v102, v102
  v_exp_f32 v103, v103
  v_pk_mul_f32 v[162:163], v[162:163], v[70:71]
  v_pk_mul_f32 v[166:167], v[166:167], v[70:71]
  v_pk_mul_f32 v[170:171], v[170:171], v[70:71]
  v_pk_mul_f32 v[174:175], v[174:175], v[70:71]
  v_pk_add_f32 v[96:97], v[96:97], v[38:39]
  v_pk_add_f32 v[98:99], v[98:99], v[38:39]
  v_pk_add_f32 v[100:101], v[100:101], v[38:39]
  v_pk_add_f32 v[102:103], v[102:103], v[38:39]
  v_rcp_f32 v96, v96
  v_rcp_f32 v97, v97
  v_rcp_f32 v98, v98
  v_rcp_f32 v99, v99
  v_rcp_f32 v100, v100
  v_rcp_f32 v101, v101
  v_rcp_f32 v102, v102
  v_rcp_f32 v103, v103
  v_pk_fma_f32 v[104:105], v[162:163], v[96:97], v[104:105]
  v_pk_fma_f32 v[106:107], v[166:167], v[98:99], v[106:107]
  v_pk_fma_f32 v[108:109], v[170:171], v[100:101], v[108:109]
  v_pk_fma_f32 v[110:111], v[174:175], v[102:103], v[110:111]
  v_pk_mul_f32 v[96:97], v[176:177], v[176:177]
  v_pk_mul_f32 v[98:99], v[180:181], v[180:181]
  v_pk_mul_f32 v[100:101], v[184:185], v[184:185]
  v_pk_mul_f32 v[102:103], v[188:189], v[188:189]
  v_pk_fma_f32 v[96:97], v[96:97], s[60:61], v[36:37]
  v_pk_fma_f32 v[98:99], v[98:99], s[60:61], v[36:37]
  v_pk_fma_f32 v[100:101], v[100:101], s[60:61], v[36:37]
  v_pk_fma_f32 v[102:103], v[102:103], s[60:61], v[36:37]
  v_pk_mul_f32 v[96:97], v[96:97], v[176:177]
  v_pk_mul_f32 v[98:99], v[98:99], v[180:181]
  v_pk_mul_f32 v[100:101], v[100:101], v[184:185]
  v_pk_mul_f32 v[102:103], v[102:103], v[188:189]
  v_exp_f32 v96, v96
  v_exp_f32 v97, v97
  v_exp_f32 v98, v98
  v_exp_f32 v99, v99
  v_exp_f32 v100, v100
  v_exp_f32 v101, v101
  v_exp_f32 v102, v102
  v_exp_f32 v103, v103
  v_pk_mul_f32 v[176:177], v[176:177], v[72:73]
  v_pk_mul_f32 v[180:181], v[180:181], v[72:73]
  v_pk_mul_f32 v[184:185], v[184:185], v[72:73]
  v_pk_mul_f32 v[188:189], v[188:189], v[72:73]
  v_pk_add_f32 v[96:97], v[96:97], v[38:39]
  v_pk_add_f32 v[98:99], v[98:99], v[38:39]
  v_pk_add_f32 v[100:101], v[100:101], v[38:39]
  v_pk_add_f32 v[102:103], v[102:103], v[38:39]
  v_rcp_f32 v96, v96
  v_rcp_f32 v97, v97
  v_rcp_f32 v98, v98
  v_rcp_f32 v99, v99
  v_rcp_f32 v100, v100
  v_rcp_f32 v101, v101
  v_rcp_f32 v102, v102
  v_rcp_f32 v103, v103
  v_pk_fma_f32 v[104:105], v[176:177], v[96:97], v[104:105]
  v_pk_fma_f32 v[106:107], v[180:181], v[98:99], v[106:107]
  v_pk_fma_f32 v[108:109], v[184:185], v[100:101], v[108:109]
  v_pk_fma_f32 v[110:111], v[188:189], v[102:103], v[110:111]
  v_pk_mul_f32 v[96:97], v[178:179], v[178:179]
  v_pk_mul_f32 v[98:99], v[182:183], v[182:183]
  v_pk_mul_f32 v[100:101], v[186:187], v[186:187]
  v_pk_mul_f32 v[102:103], v[190:191], v[190:191]
  v_pk_fma_f32 v[96:97], v[96:97], s[60:61], v[36:37]
  v_pk_fma_f32 v[98:99], v[98:99], s[60:61], v[36:37]
  v_pk_fma_f32 v[100:101], v[100:101], s[60:61], v[36:37]
  v_pk_fma_f32 v[102:103], v[102:103], s[60:61], v[36:37]
  v_pk_mul_f32 v[96:97], v[96:97], v[178:179]
  v_pk_mul_f32 v[98:99], v[98:99], v[182:183]
  v_pk_mul_f32 v[100:101], v[100:101], v[186:187]
  v_pk_mul_f32 v[102:103], v[102:103], v[190:191]
  v_exp_f32 v96, v96
  v_exp_f32 v97, v97
  v_exp_f32 v98, v98
  v_exp_f32 v99, v99
  v_exp_f32 v100, v100
  v_exp_f32 v101, v101
  v_exp_f32 v102, v102
  v_exp_f32 v103, v103
  v_pk_mul_f32 v[178:179], v[178:179], v[74:75]
  v_pk_mul_f32 v[182:183], v[182:183], v[74:75]
  v_pk_mul_f32 v[186:187], v[186:187], v[74:75]
  v_pk_mul_f32 v[190:191], v[190:191], v[74:75]
  v_pk_add_f32 v[96:97], v[96:97], v[38:39]
  v_pk_add_f32 v[98:99], v[98:99], v[38:39]
  v_pk_add_f32 v[100:101], v[100:101], v[38:39]
  v_pk_add_f32 v[102:103], v[102:103], v[38:39]
  v_rcp_f32 v96, v96
  v_rcp_f32 v97, v97
  v_rcp_f32 v98, v98
  v_rcp_f32 v99, v99
  v_rcp_f32 v100, v100
  v_rcp_f32 v101, v101
  v_rcp_f32 v102, v102
  v_rcp_f32 v103, v103
  v_pk_fma_f32 v[104:105], v[178:179], v[96:97], v[104:105]
  v_pk_fma_f32 v[106:107], v[182:183], v[98:99], v[106:107]
  v_pk_fma_f32 v[108:109], v[186:187], v[100:101], v[108:109]
  v_pk_fma_f32 v[110:111], v[190:191], v[102:103], v[110:111]
  v_add_f32 v104, v104, v105
  v_add_f32 v106, v106, v107
  v_add_f32 v108, v108, v109
  v_add_f32 v110, v110, v111
  v_lshlrev_b32 v2, 2, v0
  s_lshl_b32 s45, s40, 8
  s_add_u32 s45, s45, 162048
  v_permlane32_swap_b32 v104, v108
  v_permlane32_swap_b32 v106, v110
  v_add_u32 v3, s45, v2
  v_add_f32 v104, v104, v108
  v_add_f32 v106, v106, v110
  s_nop 1
  v_permlane16_swap_b32 v104, v106
  v_add_f32 v12, v104, v106
  ds_write_b32 v3, v12
  s_waitcnt lgkmcnt(0)
  s_barrier
  s_cmp_lg_u32 s40, 0
  s_cbranch_scc1 L_end
  v_add_u32 v3, 162048, v2
  ds_read_b32 v12, v3 offset:0
  ds_read_b32 v13, v3 offset:256
  ds_read_b32 v14, v3 offset:512
  ds_read_b32 v15, v3 offset:768
  ds_read_b32 v16, v3 offset:1024
  s_lshl_b32 s45, s2, 7
  v_lshlrev_b32 v2, 1, v0
  s_waitcnt lgkmcnt(0)
  v_add_f32 v12, v12, v13
  v_add_f32 v14, v14, v15
  v_add_f32 v16, s59, v16
  v_add_f32 v12, v12, v14
  v_add_f32 v12, v12, v16
  v_cvt_pk_bf16_f32 v12, v12, v12
  buffer_store_short v12, v2, s[36:39], s45 offen
L_end:
  s_endpgm
L_prod:
  s_nop 4
  s_mov_b32 s32, s22
  s_and_b32 s33, s23, 0xffff
  s_mov_b32 s34, 849920
  s_mov_b32 s35, 0x00020000
  s_mov_b32 s68, s20
  s_and_b32 s69, s21, 0xffff
  s_mov_b32 s70, 256
  s_mov_b32 s71, 0x00020000
  s_cmp_ge_u32 s63, 50
  s_cbranch_scc1 L_produ
  s_and_b32 s46, s40, 1
  s_lshr_b32 s47, s40, 1
  s_lshl_b32 s48, s63, 1
  s_add_u32 s47, s47, s48
  s_mov_b32 s36, s10
  s_and_b32 s37, s11, 0xffff
  s_mov_b32 s38, 819200
  s_mov_b32 s39, 0x00020000
  v_lshrrev_b32 v96, 4, v0
  v_lshlrev_b32 v96, 11, v96
  v_and_b32 v97, 15, v0
  v_lshl_add_u32 v96, v97, 3, v96
  s_lshl_b32 s48, s47, 13
  s_lshl_b32 s49, s46, 7
  s_add_u32 s48, s48, s49
  buffer_load_dwordx2 v[128:129], v96, s[36:39], s48 offen offset:0
  buffer_load_dwordx2 v[130:131], v96, s[36:39], s48 offen offset:256
  buffer_load_dwordx2 v[132:133], v96, s[36:39], s48 offen offset:512
  buffer_load_dwordx2 v[134:135], v96, s[36:39], s48 offen offset:768
  buffer_load_dwordx2 v[136:137], v96, s[36:39], s48 offen offset:1024
  buffer_load_dwordx2 v[138:139], v96, s[36:39], s48 offen offset:1280
  buffer_load_dwordx2 v[140:141], v96, s[36:39], s48 offen offset:1536
  buffer_load_dwordx2 v[142:143], v96, s[36:39], s48 offen offset:1792
  s_mul_i32 s48, s46, 411648
  s_lshl_b32 s49, s47, 11
  s_add_u32 s48, s48, s49
  s_add_u32 s49, s48, 205824
  v_lshlrev_b32 v97, 4, v0
  s_mov_b32 s50, 0x05040100
  s_mov_b32 s51, 0x07060302
  s_waitcnt vmcnt(0)
  v_perm_b32 v100, v130, v128, s50
  v_perm_b32 v101, v134, v132, s50
  v_perm_b32 v102, v138, v136, s50
  v_perm_b32 v103, v142, v140, s50
  buffer_store_dwordx4 v[100:103], v97, s[32:35], s48 offen offset:0 sc0 sc1
  v_perm_b32 v104, v130, v128, s51
  v_perm_b32 v105, v134, v132, s51
  v_perm_b32 v106, v138, v136, s51
  v_perm_b32 v107, v142, v140, s51
  buffer_store_dwordx4 v[104:107], v97, s[32:35], s48 offen offset:1024 sc0 sc1
  v_perm_b32 v108, v131, v129, s50
  v_perm_b32 v109, v135, v133, s50
  v_perm_b32 v110, v139, v137, s50
  v_perm_b32 v111, v143, v141, s50
  buffer_store_dwordx4 v[108:111], v97, s[32:35], s49 offen offset:0 sc0 sc1
  v_perm_b32 v112, v131, v129, s51
  v_perm_b32 v113, v135, v133, s51
  v_perm_b32 v114, v139, v137, s51
  v_perm_b32 v115, v143, v141, s51
  buffer_store_dwordx4 v[112:115], v97, s[32:35], s49 offen offset:1024 sc0 sc1
  s_branch L_prodst
L_produ:
  s_sub_u32 s48, s63, 50
  s_lshl_b32 s48, s48, 2
  s_add_u32 s48, s48, s40
  s_mov_b32 s36, s8
  s_and_b32 s37, s9, 0xffff
  s_mov_b32 s38, 20000
  s_mov_b32 s39, 0x00020000
  v_and_b32 v94, 15, v0
  v_lshrrev_b32 v95, 4, v0
  s_cmp_ge_u32 s48, 3
  s_cbranch_scc1 L_um
  s_cmp_ge_u32 s48, 1
  s_cbranch_scc1 L_u1
  v_lshrrev_b32 v96, 2, v94
  v_mul_u32_u24 v98, 200, v95
  v_lshl_add_u32 v98, v96, 1, v98
  v_add_u32 v98, 19392, v98
  buffer_load_ushort v128, v98, s[36:39], 0 offen
  v_and_b32 v96, 3, v0
  s_waitcnt vmcnt(0)
  v_lshlrev_b32 v128, 16, v128
  v_cmp_eq_u32 vcc, 0, v96
  s_nop 1
  v_cndmask_b32 v100, 0, v128, vcc
  v_cmp_eq_u32 vcc, 1, v96
  s_nop 1
  v_cndmask_b32 v101, 0, v128, vcc
  v_cmp_eq_u32 vcc, 2, v96
  s_nop 1
  v_cndmask_b32 v102, 0, v128, vcc
  v_cmp_eq_u32 vcc, 3, v96
  s_nop 1
  v_cndmask_b32 v103, 0, v128, vcc
  s_branch L_ust
L_u1:
  s_sub_u32 s46, s48, 1
  s_lshl_b32 s46, s46, 6
  v_add_u32 v96, s46, v94
  v_mul_u32_u24 v98, 200, v95
  v_lshl_add_u32 v98, v96, 1, v98
  v_add_u32 v98, 19200, v98
  v_mul_u32_u24 v99, 200, v96
  v_lshl_add_u32 v99, v95, 1, v99
  v_add_u32 v99, 192, v99
  v_add_u32 v97, 6400, v99
  buffer_load_ushort v128, v98, s[36:39], 0 offen offset:0
  buffer_load_ushort v129, v98, s[36:39], 0 offen offset:32
  buffer_load_ushort v130, v98, s[36:39], 0 offen offset:64
  buffer_load_ushort v131, v98, s[36:39], 0 offen offset:96
  buffer_load_ushort v132, v99, s[36:39], 0 offen offset:0
  buffer_load_ushort v133, v99, s[36:39], 0 offen offset:3200
  buffer_load_ushort v134, v97, s[36:39], 0 offen offset:0
  buffer_load_ushort v135, v97, s[36:39], 0 offen offset:3200
  s_waitcnt vmcnt(0)
  v_lshlrev_b32 v128, 16, v128
  v_lshlrev_b32 v129, 16, v129
  v_lshlrev_b32 v130, 16, v130
  v_lshlrev_b32 v131, 16, v131
  v_lshlrev_b32 v132, 16, v132
  v_lshlrev_b32 v133, 16, v133
  v_lshlrev_b32 v134, 16, v134
  v_lshlrev_b32 v135, 16, v135
  v_add_f32 v100, v128, v132
  v_add_f32 v101, v129, v133
  v_add_f32 v102, v130, v134
  v_add_f32 v103, v131, v135
  s_branch L_ust
L_um:
  s_sub_u32 s46, s48, 3
  s_mov_b32 s47, 0
  s_cmp_gt_u32 s46, s47
  s_cselect_b32 s49, 1, 0
  s_add_u32 s47, s47, s49
  s_mul_i32 s49, s49, s47
  s_sub_u32 s46, s46, s49
  s_cmp_gt_u32 s46, s47
  s_cselect_b32 s49, 1, 0
  s_add_u32 s47, s47, s49
  s_mul_i32 s49, s49, s47
  s_sub_u32 s46, s46, s49
  s_cmp_gt_u32 s46, s47
  s_cselect_b32 s49, 1, 0
  s_add_u32 s47, s47, s49
  s_mul_i32 s49, s49, s47
  s_sub_u32 s46, s46, s49
  s_cmp_gt_u32 s46, s47
  s_cselect_b32 s49, 1, 0
  s_add_u32 s47, s47, s49
  s_mul_i32 s49, s49, s47
  s_sub_u32 s46, s46, s49
  s_cmp_gt_u32 s46, s47
  s_cselect_b32 s49, 1, 0
  s_add_u32 s47, s47, s49
  s_mul_i32 s49, s49, s47
  s_sub_u32 s46, s46, s49
  s_lshl_b32 s49, s47, 4
  v_add_u32 v96, s49, v94
  s_lshl_b32 s49, s46, 4
  v_lshl_add_u32 v97, v95, 2, s49
  v_mul_u32_u24 v98, 200, v97
  v_lshl_add_u32 v98, v96, 1, v98
  v_mul_u32_u24 v99, 200, v96
  v_lshl_add_u32 v99, v97, 1, v99
  s_cmp_eq_u32 s46, s47
  s_cselect_b32 s49, 0x100000, 0
  v_add_u32 v99, s49, v99
  buffer_load_ushort v128, v98, s[36:39], 0 offen offset:0
  buffer_load_ushort v129, v98, s[36:39], 0 offen offset:200
  buffer_load_ushort v130, v98, s[36:39], 0 offen offset:400
  buffer_load_ushort v131, v98, s[36:39], 0 offen offset:600
  buffer_load_dwordx2 v[132:133], v99, s[36:39], 0 offen
  s_waitcnt vmcnt(0)
  v_lshlrev_b32 v128, 16, v128
  v_lshlrev_b32 v129, 16, v129
  v_lshlrev_b32 v130, 16, v130
  v_lshlrev_b32 v131, 16, v131
  v_lshlrev_b32 v134, 16, v132
  v_and_b32 v135, 0xffff0000, v132
  v_lshlrev_b32 v136, 16, v133
  v_and_b32 v137, 0xffff0000, v133
  v_add_f32 v100, v128, v134
  v_add_f32 v101, v129, v135
  v_add_f32 v102, v130, v136
  v_add_f32 v103, v131, v137
L_ust:
  s_lshl_b32 s48, s48, 10
  s_add_u32 s48, s48, 823296
  v_lshlrev_b32 v97, 4, v0
  buffer_store_dwordx4 v[100:103], v97, s[32:35], s48 offen sc0 sc1
L_prodst:
  s_add_u32 m0, s44, 66560
  s_add_u32 s45, s42, 4096
  s_mov_b32 s24, s4
  s_and_b32 s25, s5, 0xffff
  buffer_load_dwordx4 v4, s[24:27], s42 offen offset:0 nt lds
  buffer_load_dwordx4 v4, s[24:27], s42 offen offset:1024 nt lds
  buffer_load_dwordx4 v4, s[24:27], s42 offen offset:2048 nt lds
  buffer_load_dwordx4 v4, s[24:27], s42 offen offset:3072 nt lds
  s_add_u32 m0, m0, 4096
  s_nop 0
  buffer_load_dwordx4 v4, s[24:27], s45 offen offset:0 nt lds
  buffer_load_dwordx4 v4, s[24:27], s45 offen offset:1024 nt lds
  s_mov_b64 exec, 0xffff
  buffer_load_dwordx4 v4, s[24:27], s45 offen offset:2048 nt lds
  s_mov_b64 exec, -1
  s_waitcnt vmcnt(7)
  s_barrier
  s_cmp_lg_u32 s40, 0
  s_cbranch_scc1 L_nosig
  v_lshlrev_b32 v96, 7, v0
  v_mov_b32 v97, 1
  s_mov_b64 exec, 3
  buffer_atomic_add v97, v96, s[68:71], 0 offen sc1
  s_mov_b64 exec, -1
  s_waitcnt vmcnt(1)
  s_branch L_sigdone
L_nosig:
  s_waitcnt vmcnt(0)
L_sigdone:
  s_mov_b32 s28, s6
  s_and_b32 s29, s7, 0xffff
  s_mov_b32 s30, 6400000
  s_mov_b32 s31, 0x00020000
  v_and_b32 v2, 3, v0
  v_lshrrev_b32 v3, 4, v0
  v_sub_u32 v1, 0, v3
  v_and_b32 v1, 3, v1
  v_xor_b32 v1, v1, v2
  v_lshlrev_b32 v1, 4, v1
  v_xor_b32 v6, 16, v1
  v_mul_u32_u24 v5, 400, v2
  v_lshrrev_b32 v8, 2, v0
  v_lshl_add_u32 v5, v8, 2, v5
  s_add_u32 s45, s44, 66560
  v_add_u32 v5, s45, v5
  v_mul_u32_u24 v7, 1600, v2
  v_and_b32 v8, 3, v8
  v_mul_u32_u24 v8, 400, v8
  v_add_u32 v7, v7, v8
  v_lshl_add_u32 v7, v3, 2, v7
  v_add_u32 v7, s45, v7
  s_lshl_b32 s74, s40, 12
  s_add_u32 s74, s74, 145408
  ds_read_b32 v32, v7 offset:384
  ds_read_b32 v192, v5 offset:0
  ds_read_b32 v196, v5 offset:1600
  ds_read_b32 v200, v5 offset:3200
  ds_read_b32 v204, v5 offset:4800
  ds_read_b32 v193, v5 offset:64
  ds_read_b32 v197, v5 offset:1664
  ds_read_b32 v201, v5 offset:3264
  ds_read_b32 v205, v5 offset:4864
  ds_read_b32 v194, v5 offset:128
  ds_read_b32 v198, v5 offset:1728
  ds_read_b32 v202, v5 offset:3328
  ds_read_b32 v206, v5 offset:4928
  s_waitcnt lgkmcnt(12)
  v_lshlrev_b32 v32, 6, v32
  s_add_u32 m0, s74, 0
  s_nop 0
  v_add_u32_dpp v2, v32, v1 quad_perm:[0,0,0,0] row_mask:0xf bank_mask:0xf
  buffer_load_dwordx4 v2, s[28:31], 0 offen lds
  s_add_u32 m0, s74, 1024
  v_add_u32_dpp v3, v32, v1 quad_perm:[1,1,1,1] row_mask:0xf bank_mask:0xf
  buffer_load_dwordx4 v3, s[28:31], 0 offen lds
  s_add_u32 m0, s74, 2048
  v_add_u32_dpp v2, v32, v1 quad_perm:[2,2,2,2] row_mask:0xf bank_mask:0xf
  buffer_load_dwordx4 v2, s[28:31], 0 offen lds
  s_add_u32 m0, s74, 3072
  v_add_u32_dpp v3, v32, v1 quad_perm:[3,3,3,3] row_mask:0xf bank_mask:0xf
  buffer_load_dwordx4 v3, s[28:31], 0 offen lds
  s_waitcnt lgkmcnt(11)
  v_lshlrev_b32 v192, 6, v192
  s_add_u32 m0, s44, 0
  s_nop 0
  v_add_u32_dpp v2, v192, v1 quad_perm:[0,0,0,0] row_mask:0xf bank_mask:0xf
  buffer_load_dwordx4 v2, s[28:31], 0 offen lds
  s_and_b32 s45, s2, 1
  s_lshl_b32 s45, s45, 7
  v_mov_b32 v120, s45
  s_waitcnt lgkmcnt(0)
  ds_read_b32 v195, v5 offset:192
  ds_read_b32 v199, v5 offset:1792
  ds_read_b32 v203, v5 offset:3392
  ds_read_b32 v207, v5 offset:4992
  ds_read_b32 v252, v5 offset:256
  ds_read_b32 v253, v5 offset:1856
  ds_read_b32 v254, v5 offset:3456
  ds_read_b32 v255, v5 offset:5056
  ds_read_b32 v92, v5 offset:320
  ds_read_b32 v93, v5 offset:1920
  ds_read_b32 v94, v5 offset:3520
  ds_read_b32 v95, v5 offset:5120
  s_add_u32 m0, s44, 1040
  v_add_u32_dpp v3, v192, v1 quad_perm:[1,1,1,1] row_mask:0xf bank_mask:0xf
  buffer_load_dwordx4 v3, s[28:31], 0 offen lds
  s_add_u32 m0, s44, 2080
  v_add_u32_dpp v2, v192, v1 quad_perm:[2,2,2,2] row_mask:0xf bank_mask:0xf
  buffer_load_dwordx4 v2, s[28:31], 0 offen lds
  s_add_u32 m0, s44, 3120
  v_add_u32_dpp v3, v192, v1 quad_perm:[3,3,3,3] row_mask:0xf bank_mask:0xf
  buffer_load_dwordx4 v3, s[28:31], 0 offen lds
  v_lshlrev_b32 v196, 6, v196
  s_add_u32 m0, s44, 4160
  s_nop 0
  v_add_u32_dpp v2, v196, v6 quad_perm:[0,0,0,0] row_mask:0xf bank_mask:0xf
  buffer_load_dwordx4 v2, s[28:31], 0 offen lds
  s_add_u32 m0, s44, 5200
  v_add_u32_dpp v3, v196, v6 quad_perm:[1,1,1,1] row_mask:0xf bank_mask:0xf
  buffer_load_dwordx4 v3, s[28:31], 0 offen lds
  s_add_u32 m0, s44, 6240
  v_add_u32_dpp v2, v196, v6 quad_perm:[2,2,2,2] row_mask:0xf bank_mask:0xf
  buffer_load_dwordx4 v2, s[28:31], 0 offen lds
  s_add_u32 m0, s44, 7280
  v_add_u32_dpp v3, v196, v6 quad_perm:[3,3,3,3] row_mask:0xf bank_mask:0xf
  buffer_load_dwordx4 v3, s[28:31], 0 offen lds
  v_lshlrev_b32 v200, 6, v200
  s_add_u32 m0, s44, 8320
  s_nop 0
  v_add_u32_dpp v2, v200, v6 quad_perm:[0,0,0,0] row_mask:0xf bank_mask:0xf
  buffer_load_dwordx4 v2, s[28:31], 0 offen lds
  s_add_u32 m0, s44, 9360
  v_add_u32_dpp v3, v200, v6 quad_perm:[1,1,1,1] row_mask:0xf bank_mask:0xf
  buffer_load_dwordx4 v3, s[28:31], 0 offen lds
  s_add_u32 m0, s44, 10400
  v_add_u32_dpp v2, v200, v6 quad_perm:[2,2,2,2] row_mask:0xf bank_mask:0xf
  buffer_load_dwordx4 v2, s[28:31], 0 offen lds
  s_add_u32 m0, s44, 11440
  v_add_u32_dpp v3, v200, v6 quad_perm:[3,3,3,3] row_mask:0xf bank_mask:0xf
  buffer_load_dwordx4 v3, s[28:31], 0 offen lds
  v_lshlrev_b32 v204, 6, v204
  s_add_u32 m0, s44, 12480
  s_nop 0
  v_add_u32_dpp v2, v204, v1 quad_perm:[0,0,0,0] row_mask:0xf bank_mask:0xf
  buffer_load_dwordx4 v2, s[28:31], 0 offen lds
  s_add_u32 m0, s44, 13520
  v_add_u32_dpp v3, v204, v1 quad_perm:[1,1,1,1] row_mask:0xf bank_mask:0xf
  buffer_load_dwordx4 v3, s[28:31], 0 offen lds
  s_add_u32 m0, s44, 14560
  v_add_u32_dpp v2, v204, v1 quad_perm:[2,2,2,2] row_mask:0xf bank_mask:0xf
  buffer_load_dwordx4 v2, s[28:31], 0 offen lds
  s_add_u32 m0, s44, 15600
  v_add_u32_dpp v3, v204, v1 quad_perm:[3,3,3,3] row_mask:0xf bank_mask:0xf
  buffer_load_dwordx4 v3, s[28:31], 0 offen lds
  s_cmp_lg_u32 s40, 0
  s_cbranch_scc1 L_npp
  buffer_load_dword v112, v120, s[68:71], 0 offen sc1
L_npp:
  s_lshl_b32 s41, s40, 10
  s_mul_i32 s43, s40, 205824
  s_add_u32 s43, s43, 196608
  s_add_u32 s62, s43, 4096
  s_add_u32 s73, s41, 823296
  v_lshrrev_b32 v2, 4, v0
  v_lshlrev_b32 v2, 5, v2
  s_lshr_b32 s45, s40, 1
  s_lshl_b32 s45, s45, 7
  s_and_b32 s75, s40, 1
  s_lshl_b32 s75, s75, 2
  s_add_u32 s75, s75, s45
  v_add_u32 v2, s75, v2
  s_mov_b32 s36, s12
  s_and_b32 s37, s13, 0xffff
  s_mov_b32 s38, 256
  s_mov_b32 s39, 0x00020000
  buffer_load_dword v96, v2, s[36:39], 0 offen offset:0
  buffer_load_dword v97, v2, s[36:39], 0 offen offset:8
  buffer_load_dword v98, v2, s[36:39], 0 offen offset:16
  buffer_load_dword v99, v2, s[36:39], 0 offen offset:24
  s_mov_b32 s36, s16
  s_and_b32 s37, s17, 0xffff
  s_mov_b32 s38, 2
  s_mov_b32 s39, 0x00020000
  buffer_load_ushort v121, off, s[36:39], 0
  s_mov_b32 s36, s14
  s_and_b32 s37, s15, 0xffff
  s_mov_b32 s38, 256
  s_mov_b32 s39, 0x00020000
  s_mov_b32 m0, 161792
  v_lshlrev_b32 v2, 2, v0
  buffer_load_dword v2, s[36:39], 0 offen lds
  s_branch L_join
L_codeend:
.section .rodata,"a"
.p2align 6
.amdhsa_kernel standalone__deep_cross_pnn__recsys_kernel
  .amdhsa_next_free_vgpr 512
  .amdhsa_next_free_sgpr 102
  .amdhsa_accum_offset 256
  .amdhsa_group_segment_fixed_size 0
  .amdhsa_kernarg_size 80
  .amdhsa_user_sgpr_count 2
  .amdhsa_user_sgpr_kernarg_segment_ptr 1
  .amdhsa_system_sgpr_workgroup_id_x 1
  .amdhsa_float_denorm_mode_32 3
.end_amdhsa_kernel
```
